```python
import torch

def _softmax(x, axis=-1):
    return torch.softmax(x, dim=axis)
def _gelu(x):
    return torch.nn.functional.gelu(x, approximate="tanh")
def _silu(x):
    return torch.nn.functional.silu(x)
def _sigmoid(x):
    return torch.sigmoid(x)
def _layernorm(x, axis=-1, eps=1e-5):
    m = x.mean(dim=axis, keepdim=True)
    v = x.var(dim=axis, keepdim=True, unbiased=False)
    return (x - m) / torch.sqrt(v + eps)
def _scatter_add(tgt, idx, src, axis=0):
    return tgt.clone().index_add_(axis, idx, src)
def _segment_sum(src, seg, n):
    out = torch.zeros((n,) + src.shape[1:], dtype=src.dtype)
    return out.index_add_(0, seg, src)
def _pad(x, pw):
    flat = tuple(v for pair in reversed(pw) for v in pair)
    return torch.nn.functional.pad(x, flat)

kernel_name = 'concat_heads__compressed_kv_cla__sliding_block_cached__decode'

def setup_inputs():

    _w = (lambda a: (lambda t: t.to(torch.bfloat16) if t.is_floating_point() else t)(torch.as_tensor(a)))
    def _A_setup():
        B, H, Sq, Sk, D, M = 2, 32, 1, 8192, 128, 512
        Dc = 4 * D
        return {
            "x": _w((lambda *s: torch.randn(*s, dtype=torch.bfloat16) * 3.2)(B, Sq, M)),
            "c_kv": _w((lambda *s: torch.randn(*s, dtype=torch.bfloat16) * 0.1)(B, Sk, Dc)),
            "w_q": _w((lambda *s: torch.randn(*s, dtype=torch.bfloat16) * 6.4)(M, H, D) * (M ** -0.5)),
            "w_uk": _w((lambda *s: torch.randn(*s, dtype=torch.bfloat16) * 6.4)(Dc, H, D) * (Dc ** -0.5)),
            "w_uv": _w((lambda *s: torch.randn(*s, dtype=torch.bfloat16) * 0.1)(Dc, H, D) * (Dc ** -0.5)),
            "w_o": _w((lambda *s: torch.randn(*s, dtype=torch.bfloat16) * 0.1)(H, D, M) * ((H * D) ** -0.5)),
        }
    _A_in = _A_setup()

    def _B_setup():
        B, Sq, D = 2, 1, 512
        Hq, Hkv, Sk, Dh = 32, 32, 8192, 128
        assert Hq % Hkv == 0, (Hq, Hkv)
        return {
            "x": _w((lambda *s: torch.randn(*s, dtype=torch.bfloat16) * 1.6)(B, Sq, D)),
            "k_cache": _w((lambda *s: torch.randn(*s, dtype=torch.bfloat16) * 1.6)(B, Hkv, Sk, Dh)),
            "v_cache": _w((lambda *s: torch.randn(*s, dtype=torch.bfloat16) * 0.05)(B, Hkv, Sk, Dh)),
            "wq": _w((lambda *s: torch.randn(*s, dtype=torch.bfloat16) * 1.6)(D, Hq * Dh) * (D ** -0.5)),
            "wo": _w((lambda *s: torch.randn(*s, dtype=torch.bfloat16) * 0.05)(Hq * Dh, D) * ((Hq * Dh) ** -0.5)),
        }
    _B_in = _B_setup()

    return {
        "A_x": _A_in["x"],
        "A_c_kv": _A_in["c_kv"],
        "A_w_q": _A_in["w_q"],
        "A_w_uk": _A_in["w_uk"],
        "A_w_uv": _A_in["w_uv"],
        "A_w_o": _A_in["w_o"],
        "B_x": _B_in["x"],
        "B_k_cache": _B_in["k_cache"],
        "B_v_cache": _B_in["v_cache"],
        "B_wq": _B_in["wq"],
        "B_wo": _B_in["wo"],
    }

def reference(A_x, A_c_kv, A_w_q, A_w_uk, A_w_uv, A_w_o, B_x, B_k_cache, B_v_cache, B_wq, B_wo):
    def _A_ref(x, c_kv, w_q, w_uk, w_uv, w_o):
        B, Sq, M = x.shape[0], x.shape[1], x.shape[2]
        Sk = c_kv.shape[1]
        H, D = w_q.shape[1], w_q.shape[2]
        q = torch.einsum("bqm,mhd->bhqd", x, w_q)
        k = torch.einsum("bkc,chd->bhkd", c_kv, w_uk)
        v = torch.einsum("bkc,chd->bhkd", c_kv, w_uv)
        scores = torch.einsum("bhqd,bhkd->bhqk", q, k) * (D ** -0.5)
        off = Sk - Sq
        qi = torch.arange(Sq)[:, None]
        kj = torch.arange(Sk)[None, :]
        cmask = kj <= (qi + off)
        scores = torch.where(cmask[None, None], scores, -1e9)
        p = _softmax(scores, axis=-1)
        ctx = torch.einsum("bhqk,bhkd->bhqd", p, v)
        return torch.einsum("bhqd,hdm->bqm", ctx, w_o)

    def _B_ref(x, k_cache, v_cache, wq, wo):
        B, Sq, D = x.shape
        Hq, Dh = 32, 128
        Hkv, Sk = k_cache.shape[1], k_cache.shape[2]
        W = min(4096, max(256, Sk // 4))
        rep = Hq // Hkv
        q = (lambda x, *d: x.permute(*d))((x @ wq).reshape(B, Sq, Hq, Dh), 0, 2, 1, 3)
        k = (lambda x, n, axis: torch.repeat_interleave(x, n, dim=axis))(k_cache[:, :, Sk - W:, :], rep, axis=1)
        v = (lambda x, n, axis: torch.repeat_interleave(x, n, dim=axis))(v_cache[:, :, Sk - W:, :], rep, axis=1)
        scores = torch.einsum("bhqd,bhkd->bhqk", q, k) * (Dh ** -0.5)
        p = _softmax(scores, axis=-1)
        o = torch.einsum("bhqk,bhkd->bhqd", p, v)
        return (lambda x, *d: x.permute(*d))(o, 0, 2, 1, 3).reshape(B, Sq, Hq * Dh) @ wo

    a = _A_ref(A_x, A_c_kv, A_w_q, A_w_uk, A_w_uv, A_w_o)
    b = _B_ref(B_x, B_k_cache, B_v_cache, B_wq, B_wo)
    return torch.concatenate([a, b], axis=-1)
```

```asm
; @launch kernel=k1_kernel grid=(256,1,1) block=(256,1,1) lds=142336
; @launch kernel=k2_kernel grid=(32,1,1) block=(256,1,1) lds=1024
.amdgcn_target "amdgcn-amd-amdhsa--gfx950"
.text
.globl k1_kernel
.p2align 8
.type k1_kernel,@function
k1_kernel:
    s_cmp_ge_u32 s2, 256
    s_cbranch_scc1 K1_END
    s_load_dwordx16 s[16:31], s[0:1], 0
    s_load_dwordx8 s[32:39], s[0:1], 64
    s_load_dwordx4 s[40:43], s[0:1], 96
    s_and_b32 s3, s2, 7
    s_lshr_b32 s4, s2, 3
    v_lshrrev_b32 v1, 6, v0
    v_and_b32 v2, 63, v0
    v_readfirstlane_b32 s5, v1
    s_mov_b32 s45, 0x3db504f3
    s_mov_b32 s46, 0xffff0000
    s_mov_b32 s47, 0x3fb8aa3b
    v_and_b32 v3, 15, v2
    v_lshrrev_b32 v4, 4, v2
    s_lshr_b32 s7, s4, 3
    s_lshl_b32 s6, s3, 2
    s_add_u32 s7, s7, s6
    s_and_b32 s4, s4, 7
    s_lshl_b32 s70, s7, 2
    s_waitcnt lgkmcnt(0)
    s_mov_b32 s64, s42
    s_mov_b32 s65, s43
    s_mov_b32 s66, 8388608
    s_mov_b32 s67, 0x00020000
    s_mov_b32 s72, s40
    s_mov_b32 s73, s41
    s_mov_b32 s74, 256
    s_mov_b32 s75, 0x00020000
    s_cmp_ge_u32 s4, 4
    s_cbranch_scc1 K1_A
    s_mov_b32 s71, s4
    s_mov_b32 s76, s22
    s_mov_b32 s77, s23
    s_mov_b32 s78, 4194304
    s_mov_b32 s79, 0x00020000
    s_lshl_b32 s12, s5, 5
    s_lshl_b32 s6, s71, 7
    s_add_u32 s6, s6, s12
    v_add_u32 v9, s6, v3
    v_lshlrev_b32 v9, 13, v9
    s_lshl_b32 s6, s7, 8
    v_lshlrev_b32 v10, 4, v4
    v_add3_u32 v9, v9, s6, v10
    s_mov_b32 s6, 0
    buffer_load_dwordx4 v[192:195], v9, s[76:79], s6 offen offset:0 nt
    buffer_load_dwordx4 v[196:199], v9, s[76:79], s6 offen offset:64 nt
    buffer_load_dwordx4 v[200:203], v9, s[76:79], s6 offen offset:128 nt
    buffer_load_dwordx4 v[204:207], v9, s[76:79], s6 offen offset:192 nt
    s_add_u32 s6, s6, 16*8192
    buffer_load_dwordx4 v[208:211], v9, s[76:79], s6 offen offset:0 nt
    buffer_load_dwordx4 v[212:215], v9, s[76:79], s6 offen offset:64 nt
    buffer_load_dwordx4 v[216:219], v9, s[76:79], s6 offen offset:128 nt
    buffer_load_dwordx4 v[220:223], v9, s[76:79], s6 offen offset:192 nt
    s_add_u32 s6, s6, 16*8192
    s_lshr_b32 s8, s4, 1
    s_and_b32 s9, s4, 1
    s_lshl_b32 s10, s8, 5
    s_add_u32 s10, s10, s7
    s_lshl_b32 s11, s10, 21
    s_lshl_b32 s12, s9, 18
    s_add_u32 s11, s11, s12
    s_add_u32 s11, s11, 6144*256
    s_add_u32 s52, s30, s11
    s_addc_u32 s53, s31, 0
    s_mov_b32 s54, 262144
    s_mov_b32 s55, 0x00020000
    s_add_u32 s56, s32, s11
    s_addc_u32 s57, s33, 0
    s_mov_b32 s58, 262144
    s_mov_b32 s59, 0x00020000
    v_lshlrev_b32 v9, 4, v2
    s_lshl_b32 s85, s5, 10
    s_mov_b32 s86, s85
    buffer_load_dwordx4 a[0:3], v9, s[52:55], s85 offen nt
    s_add_u32 s85, s85, 4096
    buffer_load_dwordx4 a[4:7], v9, s[52:55], s85 offen nt
    s_add_u32 s85, s85, 4096
    buffer_load_dwordx4 a[8:11], v9, s[52:55], s85 offen nt
    s_add_u32 s85, s85, 4096
    buffer_load_dwordx4 a[12:15], v9, s[52:55], s85 offen nt
    s_add_u32 s85, s85, 4096
    buffer_load_dwordx4 a[16:19], v9, s[52:55], s85 offen nt
    s_add_u32 s85, s85, 4096
    buffer_load_dwordx4 a[20:23], v9, s[52:55], s85 offen nt
    s_add_u32 s85, s85, 4096
    buffer_load_dwordx4 a[24:27], v9, s[52:55], s85 offen nt
    s_add_u32 s85, s85, 4096
    buffer_load_dwordx4 a[28:31], v9, s[52:55], s85 offen nt
    s_add_u32 s85, s85, 4096
    buffer_load_dwordx4 a[32:35], v9, s[52:55], s85 offen nt
    s_add_u32 s85, s85, 4096
    buffer_load_dwordx4 a[36:39], v9, s[52:55], s85 offen nt
    s_add_u32 s85, s85, 4096
    buffer_load_dwordx4 a[40:43], v9, s[52:55], s85 offen nt
    s_add_u32 s85, s85, 4096
    buffer_load_dwordx4 a[44:47], v9, s[52:55], s85 offen nt
    s_add_u32 s85, s85, 4096
    buffer_load_dwordx4 a[48:51], v9, s[52:55], s85 offen nt
    s_add_u32 s85, s85, 4096
    buffer_load_dwordx4 a[52:55], v9, s[52:55], s85 offen nt
    s_add_u32 s85, s85, 4096
    buffer_load_dwordx4 a[56:59], v9, s[52:55], s85 offen nt
    s_add_u32 s85, s85, 4096
    buffer_load_dwordx4 a[60:63], v9, s[52:55], s85 offen nt
    s_add_u32 s85, s85, 4096
    buffer_load_dwordx4 a[64:67], v9, s[52:55], s85 offen nt
    s_add_u32 s85, s85, 4096
    buffer_load_dwordx4 a[68:71], v9, s[52:55], s85 offen nt
    s_add_u32 s85, s85, 4096
    buffer_load_dwordx4 a[72:75], v9, s[52:55], s85 offen nt
    s_add_u32 s85, s85, 4096
    buffer_load_dwordx4 a[76:79], v9, s[52:55], s85 offen nt
    s_add_u32 s85, s85, 4096
    s_waitcnt vmcnt(19)
    buffer_load_dwordx4 a[80:83], v9, s[52:55], s85 offen nt
    s_add_u32 s85, s85, 4096
    s_waitcnt vmcnt(19)
    buffer_load_dwordx4 a[84:87], v9, s[52:55], s85 offen nt
    s_add_u32 s85, s85, 4096
    s_waitcnt vmcnt(19)
    buffer_load_dwordx4 a[88:91], v9, s[52:55], s85 offen nt
    s_add_u32 s85, s85, 4096
    s_waitcnt vmcnt(19)
    buffer_load_dwordx4 a[92:95], v9, s[52:55], s85 offen nt
    s_add_u32 s85, s85, 4096
    s_waitcnt vmcnt(19)
    buffer_load_dwordx4 a[96:99], v9, s[52:55], s85 offen nt
    s_add_u32 s85, s85, 4096
    s_waitcnt vmcnt(19)
    buffer_load_dwordx4 a[100:103], v9, s[52:55], s85 offen nt
    s_add_u32 s85, s85, 4096
    s_waitcnt vmcnt(19)
    buffer_load_dwordx4 a[104:107], v9, s[52:55], s85 offen nt
    s_add_u32 s85, s85, 4096
    s_waitcnt vmcnt(19)
    buffer_load_dwordx4 a[108:111], v9, s[52:55], s85 offen nt
    s_add_u32 s85, s85, 4096
    s_waitcnt vmcnt(19)
    buffer_load_dwordx4 a[112:115], v9, s[52:55], s85 offen nt
    s_add_u32 s85, s85, 4096
    s_waitcnt vmcnt(19)
    buffer_load_dwordx4 a[116:119], v9, s[52:55], s85 offen nt
    s_add_u32 s85, s85, 4096
    s_waitcnt vmcnt(19)
    buffer_load_dwordx4 a[120:123], v9, s[52:55], s85 offen nt
    s_add_u32 s85, s85, 4096
    s_waitcnt vmcnt(19)
    buffer_load_dwordx4 a[124:127], v9, s[52:55], s85 offen nt
    s_add_u32 s85, s85, 4096
    s_waitcnt vmcnt(19)
    buffer_load_dwordx4 a[128:131], v9, s[52:55], s85 offen nt
    s_add_u32 s85, s85, 4096
    s_waitcnt vmcnt(19)
    buffer_load_dwordx4 a[132:135], v9, s[52:55], s85 offen nt
    s_add_u32 s85, s85, 4096
    s_waitcnt vmcnt(19)
    buffer_load_dwordx4 a[136:139], v9, s[52:55], s85 offen nt
    s_add_u32 s85, s85, 4096
    s_waitcnt vmcnt(19)
    buffer_load_dwordx4 a[140:143], v9, s[52:55], s85 offen nt
    s_add_u32 s85, s85, 4096
    s_cmp_lg_u32 s5, 0
    s_cbranch_scc1 K1A_P0_OK
K1A_P0_L:
    buffer_load_dword v11, off, s[72:75], s70 offset:128 sc1
    s_waitcnt vmcnt(0)
    v_readfirstlane_b32 s13, v11
    s_nop 0
    s_and_b32 s13, s13, 255
    s_cmp_ge_u32 s13, 4
    s_cbranch_scc1 K1A_P0_OK
    s_sleep 1
    s_branch K1A_P0_L
K1A_P0_OK:
    s_barrier
    s_lshl_b32 s12, s7, 13
    s_add_u32 s12, s12, 0x600000
    v_lshlrev_b32 v10, 2, v0
    s_add_u32 s13, s12, 4096
    buffer_load_dword v224, v10, s[64:67], s12 offen offset:0 sc1
    buffer_load_dword v225, v10, s[64:67], s12 offen offset:2048 sc1
    buffer_load_dword v226, v10, s[64:67], s13 offen offset:0 sc1
    buffer_load_dword v227, v10, s[64:67], s13 offen offset:2048 sc1
    s_waitcnt vmcnt(0)
    v_add_f32 v224, v224, v225
    v_add_f32 v226, v226, v227
    v_add_f32 v224, v224, v226
    v_cvt_pk_bf16_f32 v224, v224, v224
    v_lshlrev_b32 v10, 1, v0
    v_add_u32 v10, 141312, v10
    ds_write_b16 v10, v224
    s_waitcnt lgkmcnt(0)
    s_barrier
    v_and_b32 v10, 1, v2
    v_lshlrev_b32 v10, 8, v10
    v_lshl_add_u32 v10, v4, 4, v10
    v_add_u32 v10, 0x22800, v10
    ds_read_b128 v[160:163], v10 offset:0
    ds_read_b128 v[164:167], v10 offset:64
    ds_read_b128 v[168:171], v10 offset:128
    ds_read_b128 v[172:175], v10 offset:192
    v_lshlrev_b32 v10, 15, v3
    v_lshrrev_b32 v11, 1, v4
    v_lshl_add_u32 v10, v11, 9, v10
    v_and_b32 v11, 1, v4
    v_lshl_add_u32 v10, v11, 3, v10
    s_lshl_b32 s12, s7, 4
    s_lshl_b32 s13, s5, 11
    s_add_u32 s12, s12, s13
    s_lshl_b32 s13, s71, 13
    s_add_u32 s12, s12, s13
    v_add_u32 v10, s12, v10
    s_waitcnt lgkmcnt(0)
    v_mfma_f32_16x16x32_bf16 v[176:179], v[192:195], v[160:163], 0
    v_mfma_f32_16x16x32_bf16 v[176:179], v[196:199], v[164:167], v[176:179]
    v_mfma_f32_16x16x32_bf16 v[176:179], v[200:203], v[168:171], v[176:179]
    v_mfma_f32_16x16x32_bf16 v[176:179], v[204:207], v[172:175], v[176:179]
    v_mfma_f32_16x16x32_bf16 v[180:183], v[208:211], v[160:163], 0
    v_mfma_f32_16x16x32_bf16 v[180:183], v[212:215], v[164:167], v[180:183]
    v_mfma_f32_16x16x32_bf16 v[180:183], v[216:219], v[168:171], v[180:183]
    v_mfma_f32_16x16x32_bf16 v[180:183], v[220:223], v[172:175], v[180:183]
    s_nop 7
    v_cvt_pk_bf16_f32 v176, v176, v177
    v_cvt_pk_bf16_f32 v177, v178, v179
    v_cvt_pk_bf16_f32 v180, v180, v181
    v_cvt_pk_bf16_f32 v181, v182, v183
    v_cmp_gt_u32 vcc, 2, v3
    s_and_saveexec_b64 s[68:69], vcc
    buffer_store_dwordx2 v[176:177], v10, s[64:67], 0 offen offset:0 sc1
    buffer_store_dwordx2 v[180:181], v10, s[64:67], 0 offen offset:1024 sc1
    s_mov_b64 exec, s[68:69]
    s_waitcnt vmcnt(0)
    s_barrier
    s_cmp_lg_u32 s5, 0
    s_cbranch_scc1 K1A_S1_S
    v_mov_b32 v11, 1
    s_mov_b64 exec, 1
    buffer_atomic_add v11, off, s[72:75], 0 offset:0 sc1
    s_mov_b64 exec, -1
K1A_S1_S:
    buffer_load_dwordx4 a[144:147], v9, s[52:55], s85 offen nt
    s_add_u32 s85, s85, 4096
    buffer_load_dwordx4 a[148:151], v9, s[52:55], s85 offen nt
    s_add_u32 s85, s85, 4096
    buffer_load_dwordx4 a[152:155], v9, s[52:55], s85 offen nt
    s_add_u32 s85, s85, 4096
    buffer_load_dwordx4 a[156:159], v9, s[52:55], s85 offen nt
    s_add_u32 s85, s85, 4096
    buffer_load_dwordx4 a[160:163], v9, s[52:55], s85 offen nt
    s_add_u32 s85, s85, 4096
    buffer_load_dwordx4 a[164:167], v9, s[52:55], s85 offen nt
    s_add_u32 s85, s85, 4096
    buffer_load_dwordx4 a[168:171], v9, s[52:55], s85 offen nt
    s_add_u32 s85, s85, 4096
    buffer_load_dwordx4 a[172:175], v9, s[52:55], s85 offen nt
    s_add_u32 s85, s85, 4096
    buffer_load_dwordx4 a[176:179], v9, s[52:55], s85 offen nt
    s_add_u32 s85, s85, 4096
    buffer_load_dwordx4 a[180:183], v9, s[52:55], s85 offen nt
    s_add_u32 s85, s85, 4096
    buffer_load_dwordx4 a[184:187], v9, s[52:55], s85 offen nt
    s_add_u32 s85, s85, 4096
    buffer_load_dwordx4 a[188:191], v9, s[52:55], s85 offen nt
    s_add_u32 s85, s85, 4096
    buffer_load_dwordx4 a[192:195], v9, s[52:55], s85 offen nt
    s_add_u32 s85, s85, 4096
    buffer_load_dwordx4 a[196:199], v9, s[52:55], s85 offen nt
    s_add_u32 s85, s85, 4096
    buffer_load_dwordx4 a[200:203], v9, s[52:55], s85 offen nt
    s_add_u32 s85, s85, 4096
    buffer_load_dwordx4 a[204:207], v9, s[52:55], s85 offen nt
    s_add_u32 s85, s85, 4096
    buffer_load_dwordx4 a[208:211], v9, s[52:55], s85 offen nt
    s_add_u32 s85, s85, 4096
    buffer_load_dwordx4 a[212:215], v9, s[52:55], s85 offen nt
    s_add_u32 s85, s85, 4096
    buffer_load_dwordx4 a[216:219], v9, s[52:55], s85 offen nt
    s_add_u32 s85, s85, 4096
    buffer_load_dwordx4 a[220:223], v9, s[52:55], s85 offen nt
    s_add_u32 s85, s85, 4096
    s_waitcnt vmcnt(19)
    buffer_load_dwordx4 a[224:227], v9, s[52:55], s85 offen nt
    s_add_u32 s85, s85, 4096
    s_waitcnt vmcnt(19)
    buffer_load_dwordx4 a[228:231], v9, s[52:55], s85 offen nt
    s_add_u32 s85, s85, 4096
    s_waitcnt vmcnt(19)
    buffer_load_dwordx4 a[232:235], v9, s[52:55], s85 offen nt
    s_add_u32 s85, s85, 4096
    s_waitcnt vmcnt(19)
    buffer_load_dwordx4 a[236:239], v9, s[52:55], s85 offen nt
    s_add_u32 s85, s85, 4096
    s_waitcnt vmcnt(19)
    buffer_load_dwordx4 a[240:243], v9, s[52:55], s85 offen nt
    s_add_u32 s85, s85, 4096
    s_waitcnt vmcnt(19)
    buffer_load_dwordx4 a[244:247], v9, s[52:55], s85 offen nt
    s_add_u32 s85, s85, 4096
    s_waitcnt vmcnt(19)
    buffer_load_dwordx4 a[248:251], v9, s[52:55], s85 offen nt
    s_add_u32 s85, s85, 4096
    s_waitcnt vmcnt(19)
    buffer_load_dwordx4 a[252:255], v9, s[52:55], s85 offen nt
    s_add_u32 s85, s85, 4096
    s_lshl_b32 s12, s7, 13
    s_add_u32 s12, s12, 0x600400
    s_lshl_b32 s13, s8, 9
    s_add_u32 s12, s12, s13
    v_cmp_gt_u32 vcc, 128, v0
    s_and_saveexec_b64 s[68:69], vcc
    s_cbranch_execz SQB
    v_lshlrev_b32 v10, 2, v0
    s_add_u32 s13, s12, 4096
    buffer_load_dword v224, v10, s[64:67], s12 offen offset:0 sc1
    buffer_load_dword v225, v10, s[64:67], s12 offen offset:2048 sc1
    buffer_load_dword v226, v10, s[64:67], s13 offen offset:0 sc1
    buffer_load_dword v227, v10, s[64:67], s13 offen offset:2048 sc1
    s_waitcnt vmcnt(0)
    v_add_f32 v224, v224, v225
    v_add_f32 v226, v226, v227
    v_add_f32 v224, v224, v226
    v_cvt_pk_bf16_f32 v224, v224, v224
    v_lshlrev_b32 v10, 1, v0
    v_add_u32 v10, 8192, v10
    ds_write_b16 v10, v224
SQB:
    s_mov_b64 exec, s[68:69]
    s_waitcnt lgkmcnt(0)
    s_barrier
    v_lshlrev_b32 v10, 4, v3
    ds_read_b128 v[240:243], v10 offset:8192
    s_waitcnt vmcnt(0)
    buffer_load_dwordx4 v[32:35], v9, s[56:59], s86 offen nt
    s_add_u32 s86, s86, 4096
    buffer_load_dwordx4 v[36:39], v9, s[56:59], s86 offen nt
    s_add_u32 s86, s86, 4096
    buffer_load_dwordx4 v[40:43], v9, s[56:59], s86 offen nt
    s_add_u32 s86, s86, 4096
    buffer_load_dwordx4 v[44:47], v9, s[56:59], s86 offen nt
    s_add_u32 s86, s86, 4096
    buffer_load_dwordx4 v[48:51], v9, s[56:59], s86 offen nt
    s_add_u32 s86, s86, 4096
    buffer_load_dwordx4 v[52:55], v9, s[56:59], s86 offen nt
    s_add_u32 s86, s86, 4096
    buffer_load_dwordx4 v[56:59], v9, s[56:59], s86 offen nt
    s_add_u32 s86, s86, 4096
    buffer_load_dwordx4 v[60:63], v9, s[56:59], s86 offen nt
    s_add_u32 s86, s86, 4096
    buffer_load_dwordx4 v[64:67], v9, s[56:59], s86 offen nt
    s_add_u32 s86, s86, 4096
    buffer_load_dwordx4 v[68:71], v9, s[56:59], s86 offen nt
    s_add_u32 s86, s86, 4096
    buffer_load_dwordx4 v[72:75], v9, s[56:59], s86 offen nt
    s_add_u32 s86, s86, 4096
    buffer_load_dwordx4 v[76:79], v9, s[56:59], s86 offen nt
    s_add_u32 s86, s86, 4096
    buffer_load_dwordx4 v[80:83], v9, s[56:59], s86 offen nt
    s_add_u32 s86, s86, 4096
    buffer_load_dwordx4 v[84:87], v9, s[56:59], s86 offen nt
    s_add_u32 s86, s86, 4096
    buffer_load_dwordx4 v[88:91], v9, s[56:59], s86 offen nt
    s_add_u32 s86, s86, 4096
    buffer_load_dwordx4 v[92:95], v9, s[56:59], s86 offen nt
    s_add_u32 s86, s86, 4096
    buffer_load_dwordx4 v[96:99], v9, s[56:59], s86 offen nt
    s_add_u32 s86, s86, 4096
    buffer_load_dwordx4 v[100:103], v9, s[56:59], s86 offen nt
    s_add_u32 s86, s86, 4096
    buffer_load_dwordx4 v[104:107], v9, s[56:59], s86 offen nt
    s_add_u32 s86, s86, 4096
    buffer_load_dwordx4 v[108:111], v9, s[56:59], s86 offen nt
    s_add_u32 s86, s86, 4096
    s_waitcnt lgkmcnt(0)
    v_accvgpr_read_b32 v224, a0
    v_accvgpr_read_b32 v225, a1
    v_accvgpr_read_b32 v226, a2
    v_accvgpr_read_b32 v227, a3
    v_accvgpr_read_b32 v228, a4
    v_accvgpr_read_b32 v229, a5
    v_accvgpr_read_b32 v230, a6
    v_accvgpr_read_b32 v231, a7
    v_accvgpr_read_b32 v232, a8
    v_accvgpr_read_b32 v233, a9
    v_accvgpr_read_b32 v234, a10
    v_accvgpr_read_b32 v235, a11
    v_accvgpr_read_b32 v236, a12
    v_accvgpr_read_b32 v237, a13
    v_accvgpr_read_b32 v238, a14
    v_accvgpr_read_b32 v239, a15
    v_dot2_f32_bf16 v160, v224, v240, 0
    v_dot2_f32_bf16 v161, v228, v240, 0
    v_dot2_f32_bf16 v162, v232, v240, 0
    v_dot2_f32_bf16 v163, v236, v240, 0
    v_dot2c_f32_bf16 v160, v225, v241
    v_dot2c_f32_bf16 v161, v229, v241
    v_dot2c_f32_bf16 v162, v233, v241
    v_dot2c_f32_bf16 v163, v237, v241
    v_dot2c_f32_bf16 v160, v226, v242
    v_dot2c_f32_bf16 v161, v230, v242
    v_dot2c_f32_bf16 v162, v234, v242
    v_dot2c_f32_bf16 v163, v238, v242
    v_dot2c_f32_bf16 v160, v227, v243
    v_dot2c_f32_bf16 v161, v231, v243
    v_dot2c_f32_bf16 v162, v235, v243
    v_dot2c_f32_bf16 v163, v239, v243
    buffer_load_dwordx4 v[112:115], v9, s[56:59], s86 offen nt
    s_add_u32 s86, s86, 4096
    v_accvgpr_read_b32 v224, a16
    v_accvgpr_read_b32 v225, a17
    v_accvgpr_read_b32 v226, a18
    v_accvgpr_read_b32 v227, a19
    v_accvgpr_read_b32 v228, a20
    v_accvgpr_read_b32 v229, a21
    v_accvgpr_read_b32 v230, a22
    v_accvgpr_read_b32 v231, a23
    v_accvgpr_read_b32 v232, a24
    v_accvgpr_read_b32 v233, a25
    v_accvgpr_read_b32 v234, a26
    v_accvgpr_read_b32 v235, a27
    v_accvgpr_read_b32 v236, a28
    v_accvgpr_read_b32 v237, a29
    v_accvgpr_read_b32 v238, a30
    v_accvgpr_read_b32 v239, a31
    v_dot2_f32_bf16 v164, v224, v240, 0
    v_dot2_f32_bf16 v165, v228, v240, 0
    v_dot2_f32_bf16 v166, v232, v240, 0
    v_dot2_f32_bf16 v167, v236, v240, 0
    v_dot2c_f32_bf16 v164, v225, v241
    v_dot2c_f32_bf16 v165, v229, v241
    v_dot2c_f32_bf16 v166, v233, v241
    v_dot2c_f32_bf16 v167, v237, v241
    v_dot2c_f32_bf16 v164, v226, v242
    v_dot2c_f32_bf16 v165, v230, v242
    v_dot2c_f32_bf16 v166, v234, v242
    v_dot2c_f32_bf16 v167, v238, v242
    v_dot2c_f32_bf16 v164, v227, v243
    v_dot2c_f32_bf16 v165, v231, v243
    v_dot2c_f32_bf16 v166, v235, v243
    v_dot2c_f32_bf16 v167, v239, v243
    v_add_f32_dpp v160, v160, v160 row_ror:8 row_mask:0xf bank_mask:0xf
    v_add_f32_dpp v161, v161, v161 row_ror:8 row_mask:0xf bank_mask:0xf
    v_add_f32_dpp v162, v162, v162 row_ror:8 row_mask:0xf bank_mask:0xf
    v_add_f32_dpp v163, v163, v163 row_ror:8 row_mask:0xf bank_mask:0xf
    v_add_f32_dpp v160, v160, v160 row_ror:4 row_mask:0xf bank_mask:0xf
    v_add_f32_dpp v161, v161, v161 row_ror:4 row_mask:0xf bank_mask:0xf
    v_add_f32_dpp v162, v162, v162 row_ror:4 row_mask:0xf bank_mask:0xf
    v_add_f32_dpp v163, v163, v163 row_ror:4 row_mask:0xf bank_mask:0xf
    v_add_f32_dpp v160, v160, v160 row_ror:2 row_mask:0xf bank_mask:0xf
    v_add_f32_dpp v161, v161, v161 row_ror:2 row_mask:0xf bank_mask:0xf
    v_add_f32_dpp v162, v162, v162 row_ror:2 row_mask:0xf bank_mask:0xf
    v_add_f32_dpp v163, v163, v163 row_ror:2 row_mask:0xf bank_mask:0xf
    v_add_f32_dpp v160, v160, v160 row_ror:1 row_mask:0xf bank_mask:0xf
    v_add_f32_dpp v161, v161, v161 row_ror:1 row_mask:0xf bank_mask:0xf
    v_add_f32_dpp v162, v162, v162 row_ror:1 row_mask:0xf bank_mask:0xf
    v_add_f32_dpp v163, v163, v163 row_ror:1 row_mask:0xf bank_mask:0xf
    buffer_load_dwordx4 v[116:119], v9, s[56:59], s86 offen nt
    s_add_u32 s86, s86, 4096
    v_accvgpr_read_b32 v224, a32
    v_accvgpr_read_b32 v225, a33
    v_accvgpr_read_b32 v226, a34
    v_accvgpr_read_b32 v227, a35
    v_accvgpr_read_b32 v228, a36
    v_accvgpr_read_b32 v229, a37
    v_accvgpr_read_b32 v230, a38
    v_accvgpr_read_b32 v231, a39
    v_accvgpr_read_b32 v232, a40
    v_accvgpr_read_b32 v233, a41
    v_accvgpr_read_b32 v234, a42
    v_accvgpr_read_b32 v235, a43
    v_accvgpr_read_b32 v236, a44
    v_accvgpr_read_b32 v237, a45
    v_accvgpr_read_b32 v238, a46
    v_accvgpr_read_b32 v239, a47
    v_dot2_f32_bf16 v168, v224, v240, 0
    v_dot2_f32_bf16 v169, v228, v240, 0
    v_dot2_f32_bf16 v170, v232, v240, 0
    v_dot2_f32_bf16 v171, v236, v240, 0
    v_dot2c_f32_bf16 v168, v225, v241
    v_dot2c_f32_bf16 v169, v229, v241
    v_dot2c_f32_bf16 v170, v233, v241
    v_dot2c_f32_bf16 v171, v237, v241
    v_dot2c_f32_bf16 v168, v226, v242
    v_dot2c_f32_bf16 v169, v230, v242
    v_dot2c_f32_bf16 v170, v234, v242
    v_dot2c_f32_bf16 v171, v238, v242
    v_dot2c_f32_bf16 v168, v227, v243
    v_dot2c_f32_bf16 v169, v231, v243
    v_dot2c_f32_bf16 v170, v235, v243
    v_dot2c_f32_bf16 v171, v239, v243
    v_add_f32_dpp v164, v164, v164 row_ror:8 row_mask:0xf bank_mask:0xf
    v_add_f32_dpp v165, v165, v165 row_ror:8 row_mask:0xf bank_mask:0xf
    v_add_f32_dpp v166, v166, v166 row_ror:8 row_mask:0xf bank_mask:0xf
    v_add_f32_dpp v167, v167, v167 row_ror:8 row_mask:0xf bank_mask:0xf
    v_add_f32_dpp v164, v164, v164 row_ror:4 row_mask:0xf bank_mask:0xf
    v_add_f32_dpp v165, v165, v165 row_ror:4 row_mask:0xf bank_mask:0xf
    v_add_f32_dpp v166, v166, v166 row_ror:4 row_mask:0xf bank_mask:0xf
    v_add_f32_dpp v167, v167, v167 row_ror:4 row_mask:0xf bank_mask:0xf
    v_add_f32_dpp v164, v164, v164 row_ror:2 row_mask:0xf bank_mask:0xf
    v_add_f32_dpp v165, v165, v165 row_ror:2 row_mask:0xf bank_mask:0xf
    v_add_f32_dpp v166, v166, v166 row_ror:2 row_mask:0xf bank_mask:0xf
    v_add_f32_dpp v167, v167, v167 row_ror:2 row_mask:0xf bank_mask:0xf
    v_add_f32_dpp v164, v164, v164 row_ror:1 row_mask:0xf bank_mask:0xf
    v_add_f32_dpp v165, v165, v165 row_ror:1 row_mask:0xf bank_mask:0xf
    v_add_f32_dpp v166, v166, v166 row_ror:1 row_mask:0xf bank_mask:0xf
    v_add_f32_dpp v167, v167, v167 row_ror:1 row_mask:0xf bank_mask:0xf
    buffer_load_dwordx4 v[120:123], v9, s[56:59], s86 offen nt
    s_add_u32 s86, s86, 4096
    v_accvgpr_read_b32 v224, a48
    v_accvgpr_read_b32 v225, a49
    v_accvgpr_read_b32 v226, a50
    v_accvgpr_read_b32 v227, a51
    v_accvgpr_read_b32 v228, a52
    v_accvgpr_read_b32 v229, a53
    v_accvgpr_read_b32 v230, a54
    v_accvgpr_read_b32 v231, a55
    v_accvgpr_read_b32 v232, a56
    v_accvgpr_read_b32 v233, a57
    v_accvgpr_read_b32 v234, a58
    v_accvgpr_read_b32 v235, a59
    v_accvgpr_read_b32 v236, a60
    v_accvgpr_read_b32 v237, a61
    v_accvgpr_read_b32 v238, a62
    v_accvgpr_read_b32 v239, a63
    v_dot2_f32_bf16 v172, v224, v240, 0
    v_dot2_f32_bf16 v173, v228, v240, 0
    v_dot2_f32_bf16 v174, v232, v240, 0
    v_dot2_f32_bf16 v175, v236, v240, 0
    v_dot2c_f32_bf16 v172, v225, v241
    v_dot2c_f32_bf16 v173, v229, v241
    v_dot2c_f32_bf16 v174, v233, v241
    v_dot2c_f32_bf16 v175, v237, v241
    v_dot2c_f32_bf16 v172, v226, v242
    v_dot2c_f32_bf16 v173, v230, v242
    v_dot2c_f32_bf16 v174, v234, v242
    v_dot2c_f32_bf16 v175, v238, v242
    v_dot2c_f32_bf16 v172, v227, v243
    v_dot2c_f32_bf16 v173, v231, v243
    v_dot2c_f32_bf16 v174, v235, v243
    v_dot2c_f32_bf16 v175, v239, v243
    v_add_f32_dpp v168, v168, v168 row_ror:8 row_mask:0xf bank_mask:0xf
    v_add_f32_dpp v169, v169, v169 row_ror:8 row_mask:0xf bank_mask:0xf
    v_add_f32_dpp v170, v170, v170 row_ror:8 row_mask:0xf bank_mask:0xf
    v_add_f32_dpp v171, v171, v171 row_ror:8 row_mask:0xf bank_mask:0xf
    v_add_f32_dpp v168, v168, v168 row_ror:4 row_mask:0xf bank_mask:0xf
    v_add_f32_dpp v169, v169, v169 row_ror:4 row_mask:0xf bank_mask:0xf
    v_add_f32_dpp v170, v170, v170 row_ror:4 row_mask:0xf bank_mask:0xf
    v_add_f32_dpp v171, v171, v171 row_ror:4 row_mask:0xf bank_mask:0xf
    v_add_f32_dpp v168, v168, v168 row_ror:2 row_mask:0xf bank_mask:0xf
    v_add_f32_dpp v169, v169, v169 row_ror:2 row_mask:0xf bank_mask:0xf
    v_add_f32_dpp v170, v170, v170 row_ror:2 row_mask:0xf bank_mask:0xf
    v_add_f32_dpp v171, v171, v171 row_ror:2 row_mask:0xf bank_mask:0xf
    v_add_f32_dpp v168, v168, v168 row_ror:1 row_mask:0xf bank_mask:0xf
    v_add_f32_dpp v169, v169, v169 row_ror:1 row_mask:0xf bank_mask:0xf
    v_add_f32_dpp v170, v170, v170 row_ror:1 row_mask:0xf bank_mask:0xf
    v_add_f32_dpp v171, v171, v171 row_ror:1 row_mask:0xf bank_mask:0xf
    buffer_load_dwordx4 v[124:127], v9, s[56:59], s86 offen nt
    s_add_u32 s86, s86, 4096
    v_accvgpr_read_b32 v224, a64
    v_accvgpr_read_b32 v225, a65
    v_accvgpr_read_b32 v226, a66
    v_accvgpr_read_b32 v227, a67
    v_accvgpr_read_b32 v228, a68
    v_accvgpr_read_b32 v229, a69
    v_accvgpr_read_b32 v230, a70
    v_accvgpr_read_b32 v231, a71
    v_accvgpr_read_b32 v232, a72
    v_accvgpr_read_b32 v233, a73
    v_accvgpr_read_b32 v234, a74
    v_accvgpr_read_b32 v235, a75
    v_accvgpr_read_b32 v236, a76
    v_accvgpr_read_b32 v237, a77
    v_accvgpr_read_b32 v238, a78
    v_accvgpr_read_b32 v239, a79
    v_dot2_f32_bf16 v176, v224, v240, 0
    v_dot2_f32_bf16 v177, v228, v240, 0
    v_dot2_f32_bf16 v178, v232, v240, 0
    v_dot2_f32_bf16 v179, v236, v240, 0
    v_dot2c_f32_bf16 v176, v225, v241
    v_dot2c_f32_bf16 v177, v229, v241
    v_dot2c_f32_bf16 v178, v233, v241
    v_dot2c_f32_bf16 v179, v237, v241
    v_dot2c_f32_bf16 v176, v226, v242
    v_dot2c_f32_bf16 v177, v230, v242
    v_dot2c_f32_bf16 v178, v234, v242
    v_dot2c_f32_bf16 v179, v238, v242
    v_dot2c_f32_bf16 v176, v227, v243
    v_dot2c_f32_bf16 v177, v231, v243
    v_dot2c_f32_bf16 v178, v235, v243
    v_dot2c_f32_bf16 v179, v239, v243
    v_add_f32_dpp v172, v172, v172 row_ror:8 row_mask:0xf bank_mask:0xf
    v_add_f32_dpp v173, v173, v173 row_ror:8 row_mask:0xf bank_mask:0xf
    v_add_f32_dpp v174, v174, v174 row_ror:8 row_mask:0xf bank_mask:0xf
    v_add_f32_dpp v175, v175, v175 row_ror:8 row_mask:0xf bank_mask:0xf
    v_add_f32_dpp v172, v172, v172 row_ror:4 row_mask:0xf bank_mask:0xf
    v_add_f32_dpp v173, v173, v173 row_ror:4 row_mask:0xf bank_mask:0xf
    v_add_f32_dpp v174, v174, v174 row_ror:4 row_mask:0xf bank_mask:0xf
    v_add_f32_dpp v175, v175, v175 row_ror:4 row_mask:0xf bank_mask:0xf
    v_add_f32_dpp v172, v172, v172 row_ror:2 row_mask:0xf bank_mask:0xf
    v_add_f32_dpp v173, v173, v173 row_ror:2 row_mask:0xf bank_mask:0xf
    v_add_f32_dpp v174, v174, v174 row_ror:2 row_mask:0xf bank_mask:0xf
    v_add_f32_dpp v175, v175, v175 row_ror:2 row_mask:0xf bank_mask:0xf
    v_add_f32_dpp v172, v172, v172 row_ror:1 row_mask:0xf bank_mask:0xf
    v_add_f32_dpp v173, v173, v173 row_ror:1 row_mask:0xf bank_mask:0xf
    v_add_f32_dpp v174, v174, v174 row_ror:1 row_mask:0xf bank_mask:0xf
    v_add_f32_dpp v175, v175, v175 row_ror:1 row_mask:0xf bank_mask:0xf
    buffer_load_dwordx4 v[128:131], v9, s[56:59], s86 offen nt
    s_add_u32 s86, s86, 4096
    v_accvgpr_read_b32 v224, a80
    v_accvgpr_read_b32 v225, a81
    v_accvgpr_read_b32 v226, a82
    v_accvgpr_read_b32 v227, a83
    v_accvgpr_read_b32 v228, a84
    v_accvgpr_read_b32 v229, a85
    v_accvgpr_read_b32 v230, a86
    v_accvgpr_read_b32 v231, a87
    v_accvgpr_read_b32 v232, a88
    v_accvgpr_read_b32 v233, a89
    v_accvgpr_read_b32 v234, a90
    v_accvgpr_read_b32 v235, a91
    v_accvgpr_read_b32 v236, a92
    v_accvgpr_read_b32 v237, a93
    v_accvgpr_read_b32 v238, a94
    v_accvgpr_read_b32 v239, a95
    v_dot2_f32_bf16 v180, v224, v240, 0
    v_dot2_f32_bf16 v181, v228, v240, 0
    v_dot2_f32_bf16 v182, v232, v240, 0
    v_dot2_f32_bf16 v183, v236, v240, 0
    v_dot2c_f32_bf16 v180, v225, v241
    v_dot2c_f32_bf16 v181, v229, v241
    v_dot2c_f32_bf16 v182, v233, v241
    v_dot2c_f32_bf16 v183, v237, v241
    v_dot2c_f32_bf16 v180, v226, v242
    v_dot2c_f32_bf16 v181, v230, v242
    v_dot2c_f32_bf16 v182, v234, v242
    v_dot2c_f32_bf16 v183, v238, v242
    v_dot2c_f32_bf16 v180, v227, v243
    v_dot2c_f32_bf16 v181, v231, v243
    v_dot2c_f32_bf16 v182, v235, v243
    v_dot2c_f32_bf16 v183, v239, v243
    v_add_f32_dpp v176, v176, v176 row_ror:8 row_mask:0xf bank_mask:0xf
    v_add_f32_dpp v177, v177, v177 row_ror:8 row_mask:0xf bank_mask:0xf
    v_add_f32_dpp v178, v178, v178 row_ror:8 row_mask:0xf bank_mask:0xf
    v_add_f32_dpp v179, v179, v179 row_ror:8 row_mask:0xf bank_mask:0xf
    v_add_f32_dpp v176, v176, v176 row_ror:4 row_mask:0xf bank_mask:0xf
    v_add_f32_dpp v177, v177, v177 row_ror:4 row_mask:0xf bank_mask:0xf
    v_add_f32_dpp v178, v178, v178 row_ror:4 row_mask:0xf bank_mask:0xf
    v_add_f32_dpp v179, v179, v179 row_ror:4 row_mask:0xf bank_mask:0xf
    v_add_f32_dpp v176, v176, v176 row_ror:2 row_mask:0xf bank_mask:0xf
    v_add_f32_dpp v177, v177, v177 row_ror:2 row_mask:0xf bank_mask:0xf
    v_add_f32_dpp v178, v178, v178 row_ror:2 row_mask:0xf bank_mask:0xf
    v_add_f32_dpp v179, v179, v179 row_ror:2 row_mask:0xf bank_mask:0xf
    v_add_f32_dpp v176, v176, v176 row_ror:1 row_mask:0xf bank_mask:0xf
    v_add_f32_dpp v177, v177, v177 row_ror:1 row_mask:0xf bank_mask:0xf
    v_add_f32_dpp v178, v178, v178 row_ror:1 row_mask:0xf bank_mask:0xf
    v_add_f32_dpp v179, v179, v179 row_ror:1 row_mask:0xf bank_mask:0xf
    buffer_load_dwordx4 v[132:135], v9, s[56:59], s86 offen nt
    s_add_u32 s86, s86, 4096
    v_accvgpr_read_b32 v224, a96
    v_accvgpr_read_b32 v225, a97
    v_accvgpr_read_b32 v226, a98
    v_accvgpr_read_b32 v227, a99
    v_accvgpr_read_b32 v228, a100
    v_accvgpr_read_b32 v229, a101
    v_accvgpr_read_b32 v230, a102
    v_accvgpr_read_b32 v231, a103
    v_accvgpr_read_b32 v232, a104
    v_accvgpr_read_b32 v233, a105
    v_accvgpr_read_b32 v234, a106
    v_accvgpr_read_b32 v235, a107
    v_accvgpr_read_b32 v236, a108
    v_accvgpr_read_b32 v237, a109
    v_accvgpr_read_b32 v238, a110
    v_accvgpr_read_b32 v239, a111
    v_dot2_f32_bf16 v184, v224, v240, 0
    v_dot2_f32_bf16 v185, v228, v240, 0
    v_dot2_f32_bf16 v186, v232, v240, 0
    v_dot2_f32_bf16 v187, v236, v240, 0
    v_dot2c_f32_bf16 v184, v225, v241
    v_dot2c_f32_bf16 v185, v229, v241
    v_dot2c_f32_bf16 v186, v233, v241
    v_dot2c_f32_bf16 v187, v237, v241
    v_dot2c_f32_bf16 v184, v226, v242
    v_dot2c_f32_bf16 v185, v230, v242
    v_dot2c_f32_bf16 v186, v234, v242
    v_dot2c_f32_bf16 v187, v238, v242
    v_dot2c_f32_bf16 v184, v227, v243
    v_dot2c_f32_bf16 v185, v231, v243
    v_dot2c_f32_bf16 v186, v235, v243
    v_dot2c_f32_bf16 v187, v239, v243
    v_add_f32_dpp v180, v180, v180 row_ror:8 row_mask:0xf bank_mask:0xf
    v_add_f32_dpp v181, v181, v181 row_ror:8 row_mask:0xf bank_mask:0xf
    v_add_f32_dpp v182, v182, v182 row_ror:8 row_mask:0xf bank_mask:0xf
    v_add_f32_dpp v183, v183, v183 row_ror:8 row_mask:0xf bank_mask:0xf
    v_add_f32_dpp v180, v180, v180 row_ror:4 row_mask:0xf bank_mask:0xf
    v_add_f32_dpp v181, v181, v181 row_ror:4 row_mask:0xf bank_mask:0xf
    v_add_f32_dpp v182, v182, v182 row_ror:4 row_mask:0xf bank_mask:0xf
    v_add_f32_dpp v183, v183, v183 row_ror:4 row_mask:0xf bank_mask:0xf
    v_add_f32_dpp v180, v180, v180 row_ror:2 row_mask:0xf bank_mask:0xf
    v_add_f32_dpp v181, v181, v181 row_ror:2 row_mask:0xf bank_mask:0xf
    v_add_f32_dpp v182, v182, v182 row_ror:2 row_mask:0xf bank_mask:0xf
    v_add_f32_dpp v183, v183, v183 row_ror:2 row_mask:0xf bank_mask:0xf
    v_add_f32_dpp v180, v180, v180 row_ror:1 row_mask:0xf bank_mask:0xf
    v_add_f32_dpp v181, v181, v181 row_ror:1 row_mask:0xf bank_mask:0xf
    v_add_f32_dpp v182, v182, v182 row_ror:1 row_mask:0xf bank_mask:0xf
    v_add_f32_dpp v183, v183, v183 row_ror:1 row_mask:0xf bank_mask:0xf
    buffer_load_dwordx4 v[136:139], v9, s[56:59], s86 offen nt
    s_add_u32 s86, s86, 4096
    v_accvgpr_read_b32 v224, a112
    v_accvgpr_read_b32 v225, a113
    v_accvgpr_read_b32 v226, a114
    v_accvgpr_read_b32 v227, a115
    v_accvgpr_read_b32 v228, a116
    v_accvgpr_read_b32 v229, a117
    v_accvgpr_read_b32 v230, a118
    v_accvgpr_read_b32 v231, a119
    v_accvgpr_read_b32 v232, a120
    v_accvgpr_read_b32 v233, a121
    v_accvgpr_read_b32 v234, a122
    v_accvgpr_read_b32 v235, a123
    v_accvgpr_read_b32 v236, a124
    v_accvgpr_read_b32 v237, a125
    v_accvgpr_read_b32 v238, a126
    v_accvgpr_read_b32 v239, a127
    v_dot2_f32_bf16 v188, v224, v240, 0
    v_dot2_f32_bf16 v189, v228, v240, 0
    v_dot2_f32_bf16 v190, v232, v240, 0
    v_dot2_f32_bf16 v191, v236, v240, 0
    v_dot2c_f32_bf16 v188, v225, v241
    v_dot2c_f32_bf16 v189, v229, v241
    v_dot2c_f32_bf16 v190, v233, v241
    v_dot2c_f32_bf16 v191, v237, v241
    v_dot2c_f32_bf16 v188, v226, v242
    v_dot2c_f32_bf16 v189, v230, v242
    v_dot2c_f32_bf16 v190, v234, v242
    v_dot2c_f32_bf16 v191, v238, v242
    v_dot2c_f32_bf16 v188, v227, v243
    v_dot2c_f32_bf16 v189, v231, v243
    v_dot2c_f32_bf16 v190, v235, v243
    v_dot2c_f32_bf16 v191, v239, v243
    v_add_f32_dpp v184, v184, v184 row_ror:8 row_mask:0xf bank_mask:0xf
    v_add_f32_dpp v185, v185, v185 row_ror:8 row_mask:0xf bank_mask:0xf
    v_add_f32_dpp v186, v186, v186 row_ror:8 row_mask:0xf bank_mask:0xf
    v_add_f32_dpp v187, v187, v187 row_ror:8 row_mask:0xf bank_mask:0xf
    v_add_f32_dpp v184, v184, v184 row_ror:4 row_mask:0xf bank_mask:0xf
    v_add_f32_dpp v185, v185, v185 row_ror:4 row_mask:0xf bank_mask:0xf
    v_add_f32_dpp v186, v186, v186 row_ror:4 row_mask:0xf bank_mask:0xf
    v_add_f32_dpp v187, v187, v187 row_ror:4 row_mask:0xf bank_mask:0xf
    v_add_f32_dpp v184, v184, v184 row_ror:2 row_mask:0xf bank_mask:0xf
    v_add_f32_dpp v185, v185, v185 row_ror:2 row_mask:0xf bank_mask:0xf
    v_add_f32_dpp v186, v186, v186 row_ror:2 row_mask:0xf bank_mask:0xf
    v_add_f32_dpp v187, v187, v187 row_ror:2 row_mask:0xf bank_mask:0xf
    v_add_f32_dpp v184, v184, v184 row_ror:1 row_mask:0xf bank_mask:0xf
    v_add_f32_dpp v185, v185, v185 row_ror:1 row_mask:0xf bank_mask:0xf
    v_add_f32_dpp v186, v186, v186 row_ror:1 row_mask:0xf bank_mask:0xf
    v_add_f32_dpp v187, v187, v187 row_ror:1 row_mask:0xf bank_mask:0xf
    buffer_load_dwordx4 v[140:143], v9, s[56:59], s86 offen nt
    s_add_u32 s86, s86, 4096
    v_accvgpr_read_b32 v224, a128
    v_accvgpr_read_b32 v225, a129
    v_accvgpr_read_b32 v226, a130
    v_accvgpr_read_b32 v227, a131
    v_accvgpr_read_b32 v228, a132
    v_accvgpr_read_b32 v229, a133
    v_accvgpr_read_b32 v230, a134
    v_accvgpr_read_b32 v231, a135
    v_accvgpr_read_b32 v232, a136
    v_accvgpr_read_b32 v233, a137
    v_accvgpr_read_b32 v234, a138
    v_accvgpr_read_b32 v235, a139
    v_accvgpr_read_b32 v236, a140
    v_accvgpr_read_b32 v237, a141
    v_accvgpr_read_b32 v238, a142
    v_accvgpr_read_b32 v239, a143
    v_dot2_f32_bf16 v192, v224, v240, 0
    v_dot2_f32_bf16 v193, v228, v240, 0
    v_dot2_f32_bf16 v194, v232, v240, 0
    v_dot2_f32_bf16 v195, v236, v240, 0
    v_dot2c_f32_bf16 v192, v225, v241
    v_dot2c_f32_bf16 v193, v229, v241
    v_dot2c_f32_bf16 v194, v233, v241
    v_dot2c_f32_bf16 v195, v237, v241
    v_dot2c_f32_bf16 v192, v226, v242
    v_dot2c_f32_bf16 v193, v230, v242
    v_dot2c_f32_bf16 v194, v234, v242
    v_dot2c_f32_bf16 v195, v238, v242
    v_dot2c_f32_bf16 v192, v227, v243
    v_dot2c_f32_bf16 v193, v231, v243
    v_dot2c_f32_bf16 v194, v235, v243
    v_dot2c_f32_bf16 v195, v239, v243
    v_add_f32_dpp v188, v188, v188 row_ror:8 row_mask:0xf bank_mask:0xf
    v_add_f32_dpp v189, v189, v189 row_ror:8 row_mask:0xf bank_mask:0xf
    v_add_f32_dpp v190, v190, v190 row_ror:8 row_mask:0xf bank_mask:0xf
    v_add_f32_dpp v191, v191, v191 row_ror:8 row_mask:0xf bank_mask:0xf
    v_add_f32_dpp v188, v188, v188 row_ror:4 row_mask:0xf bank_mask:0xf
    v_add_f32_dpp v189, v189, v189 row_ror:4 row_mask:0xf bank_mask:0xf
    v_add_f32_dpp v190, v190, v190 row_ror:4 row_mask:0xf bank_mask:0xf
    v_add_f32_dpp v191, v191, v191 row_ror:4 row_mask:0xf bank_mask:0xf
    v_add_f32_dpp v188, v188, v188 row_ror:2 row_mask:0xf bank_mask:0xf
    v_add_f32_dpp v189, v189, v189 row_ror:2 row_mask:0xf bank_mask:0xf
    v_add_f32_dpp v190, v190, v190 row_ror:2 row_mask:0xf bank_mask:0xf
    v_add_f32_dpp v191, v191, v191 row_ror:2 row_mask:0xf bank_mask:0xf
    v_add_f32_dpp v188, v188, v188 row_ror:1 row_mask:0xf bank_mask:0xf
    v_add_f32_dpp v189, v189, v189 row_ror:1 row_mask:0xf bank_mask:0xf
    v_add_f32_dpp v190, v190, v190 row_ror:1 row_mask:0xf bank_mask:0xf
    v_add_f32_dpp v191, v191, v191 row_ror:1 row_mask:0xf bank_mask:0xf
    buffer_load_dwordx4 v[144:147], v9, s[56:59], s86 offen nt
    s_add_u32 s86, s86, 4096
    v_accvgpr_read_b32 v224, a144
    v_accvgpr_read_b32 v225, a145
    v_accvgpr_read_b32 v226, a146
    v_accvgpr_read_b32 v227, a147
    v_accvgpr_read_b32 v228, a148
    v_accvgpr_read_b32 v229, a149
    v_accvgpr_read_b32 v230, a150
    v_accvgpr_read_b32 v231, a151
    v_accvgpr_read_b32 v232, a152
    v_accvgpr_read_b32 v233, a153
    v_accvgpr_read_b32 v234, a154
    v_accvgpr_read_b32 v235, a155
    v_accvgpr_read_b32 v236, a156
    v_accvgpr_read_b32 v237, a157
    v_accvgpr_read_b32 v238, a158
    v_accvgpr_read_b32 v239, a159
    v_dot2_f32_bf16 v196, v224, v240, 0
    v_dot2_f32_bf16 v197, v228, v240, 0
    v_dot2_f32_bf16 v198, v232, v240, 0
    v_dot2_f32_bf16 v199, v236, v240, 0
    v_dot2c_f32_bf16 v196, v225, v241
    v_dot2c_f32_bf16 v197, v229, v241
    v_dot2c_f32_bf16 v198, v233, v241
    v_dot2c_f32_bf16 v199, v237, v241
    v_dot2c_f32_bf16 v196, v226, v242
    v_dot2c_f32_bf16 v197, v230, v242
    v_dot2c_f32_bf16 v198, v234, v242
    v_dot2c_f32_bf16 v199, v238, v242
    v_dot2c_f32_bf16 v196, v227, v243
    v_dot2c_f32_bf16 v197, v231, v243
    v_dot2c_f32_bf16 v198, v235, v243
    v_dot2c_f32_bf16 v199, v239, v243
    v_add_f32_dpp v192, v192, v192 row_ror:8 row_mask:0xf bank_mask:0xf
    v_add_f32_dpp v193, v193, v193 row_ror:8 row_mask:0xf bank_mask:0xf
    v_add_f32_dpp v194, v194, v194 row_ror:8 row_mask:0xf bank_mask:0xf
    v_add_f32_dpp v195, v195, v195 row_ror:8 row_mask:0xf bank_mask:0xf
    v_add_f32_dpp v192, v192, v192 row_ror:4 row_mask:0xf bank_mask:0xf
    v_add_f32_dpp v193, v193, v193 row_ror:4 row_mask:0xf bank_mask:0xf
    v_add_f32_dpp v194, v194, v194 row_ror:4 row_mask:0xf bank_mask:0xf
    v_add_f32_dpp v195, v195, v195 row_ror:4 row_mask:0xf bank_mask:0xf
    v_add_f32_dpp v192, v192, v192 row_ror:2 row_mask:0xf bank_mask:0xf
    v_add_f32_dpp v193, v193, v193 row_ror:2 row_mask:0xf bank_mask:0xf
    v_add_f32_dpp v194, v194, v194 row_ror:2 row_mask:0xf bank_mask:0xf
    v_add_f32_dpp v195, v195, v195 row_ror:2 row_mask:0xf bank_mask:0xf
    v_add_f32_dpp v192, v192, v192 row_ror:1 row_mask:0xf bank_mask:0xf
    v_add_f32_dpp v193, v193, v193 row_ror:1 row_mask:0xf bank_mask:0xf
    v_add_f32_dpp v194, v194, v194 row_ror:1 row_mask:0xf bank_mask:0xf
    v_add_f32_dpp v195, v195, v195 row_ror:1 row_mask:0xf bank_mask:0xf
    buffer_load_dwordx4 v[148:151], v9, s[56:59], s86 offen nt
    s_add_u32 s86, s86, 4096
    v_accvgpr_read_b32 v224, a160
    v_accvgpr_read_b32 v225, a161
    v_accvgpr_read_b32 v226, a162
    v_accvgpr_read_b32 v227, a163
    v_accvgpr_read_b32 v228, a164
    v_accvgpr_read_b32 v229, a165
    v_accvgpr_read_b32 v230, a166
    v_accvgpr_read_b32 v231, a167
    v_accvgpr_read_b32 v232, a168
    v_accvgpr_read_b32 v233, a169
    v_accvgpr_read_b32 v234, a170
    v_accvgpr_read_b32 v235, a171
    v_accvgpr_read_b32 v236, a172
    v_accvgpr_read_b32 v237, a173
    v_accvgpr_read_b32 v238, a174
    v_accvgpr_read_b32 v239, a175
    v_dot2_f32_bf16 v200, v224, v240, 0
    v_dot2_f32_bf16 v201, v228, v240, 0
    v_dot2_f32_bf16 v202, v232, v240, 0
    v_dot2_f32_bf16 v203, v236, v240, 0
    v_dot2c_f32_bf16 v200, v225, v241
    v_dot2c_f32_bf16 v201, v229, v241
    v_dot2c_f32_bf16 v202, v233, v241
    v_dot2c_f32_bf16 v203, v237, v241
    v_dot2c_f32_bf16 v200, v226, v242
    v_dot2c_f32_bf16 v201, v230, v242
    v_dot2c_f32_bf16 v202, v234, v242
    v_dot2c_f32_bf16 v203, v238, v242
    v_dot2c_f32_bf16 v200, v227, v243
    v_dot2c_f32_bf16 v201, v231, v243
    v_dot2c_f32_bf16 v202, v235, v243
    v_dot2c_f32_bf16 v203, v239, v243
    v_add_f32_dpp v196, v196, v196 row_ror:8 row_mask:0xf bank_mask:0xf
    v_add_f32_dpp v197, v197, v197 row_ror:8 row_mask:0xf bank_mask:0xf
    v_add_f32_dpp v198, v198, v198 row_ror:8 row_mask:0xf bank_mask:0xf
    v_add_f32_dpp v199, v199, v199 row_ror:8 row_mask:0xf bank_mask:0xf
    v_add_f32_dpp v196, v196, v196 row_ror:4 row_mask:0xf bank_mask:0xf
    v_add_f32_dpp v197, v197, v197 row_ror:4 row_mask:0xf bank_mask:0xf
    v_add_f32_dpp v198, v198, v198 row_ror:4 row_mask:0xf bank_mask:0xf
    v_add_f32_dpp v199, v199, v199 row_ror:4 row_mask:0xf bank_mask:0xf
    v_add_f32_dpp v196, v196, v196 row_ror:2 row_mask:0xf bank_mask:0xf
    v_add_f32_dpp v197, v197, v197 row_ror:2 row_mask:0xf bank_mask:0xf
    v_add_f32_dpp v198, v198, v198 row_ror:2 row_mask:0xf bank_mask:0xf
    v_add_f32_dpp v199, v199, v199 row_ror:2 row_mask:0xf bank_mask:0xf
    v_add_f32_dpp v196, v196, v196 row_ror:1 row_mask:0xf bank_mask:0xf
    v_add_f32_dpp v197, v197, v197 row_ror:1 row_mask:0xf bank_mask:0xf
    v_add_f32_dpp v198, v198, v198 row_ror:1 row_mask:0xf bank_mask:0xf
    v_add_f32_dpp v199, v199, v199 row_ror:1 row_mask:0xf bank_mask:0xf
    buffer_load_dwordx4 v[152:155], v9, s[56:59], s86 offen nt
    s_add_u32 s86, s86, 4096
    v_accvgpr_read_b32 v224, a176
    v_accvgpr_read_b32 v225, a177
    v_accvgpr_read_b32 v226, a178
    v_accvgpr_read_b32 v227, a179
    v_accvgpr_read_b32 v228, a180
    v_accvgpr_read_b32 v229, a181
    v_accvgpr_read_b32 v230, a182
    v_accvgpr_read_b32 v231, a183
    v_accvgpr_read_b32 v232, a184
    v_accvgpr_read_b32 v233, a185
    v_accvgpr_read_b32 v234, a186
    v_accvgpr_read_b32 v235, a187
    v_accvgpr_read_b32 v236, a188
    v_accvgpr_read_b32 v237, a189
    v_accvgpr_read_b32 v238, a190
    v_accvgpr_read_b32 v239, a191
    v_dot2_f32_bf16 v204, v224, v240, 0
    v_dot2_f32_bf16 v205, v228, v240, 0
    v_dot2_f32_bf16 v206, v232, v240, 0
    v_dot2_f32_bf16 v207, v236, v240, 0
    v_dot2c_f32_bf16 v204, v225, v241
    v_dot2c_f32_bf16 v205, v229, v241
    v_dot2c_f32_bf16 v206, v233, v241
    v_dot2c_f32_bf16 v207, v237, v241
    v_dot2c_f32_bf16 v204, v226, v242
    v_dot2c_f32_bf16 v205, v230, v242
    v_dot2c_f32_bf16 v206, v234, v242
    v_dot2c_f32_bf16 v207, v238, v242
    v_dot2c_f32_bf16 v204, v227, v243
    v_dot2c_f32_bf16 v205, v231, v243
    v_dot2c_f32_bf16 v206, v235, v243
    v_dot2c_f32_bf16 v207, v239, v243
    v_add_f32_dpp v200, v200, v200 row_ror:8 row_mask:0xf bank_mask:0xf
    v_add_f32_dpp v201, v201, v201 row_ror:8 row_mask:0xf bank_mask:0xf
    v_add_f32_dpp v202, v202, v202 row_ror:8 row_mask:0xf bank_mask:0xf
    v_add_f32_dpp v203, v203, v203 row_ror:8 row_mask:0xf bank_mask:0xf
    v_add_f32_dpp v200, v200, v200 row_ror:4 row_mask:0xf bank_mask:0xf
    v_add_f32_dpp v201, v201, v201 row_ror:4 row_mask:0xf bank_mask:0xf
    v_add_f32_dpp v202, v202, v202 row_ror:4 row_mask:0xf bank_mask:0xf
    v_add_f32_dpp v203, v203, v203 row_ror:4 row_mask:0xf bank_mask:0xf
    v_add_f32_dpp v200, v200, v200 row_ror:2 row_mask:0xf bank_mask:0xf
    v_add_f32_dpp v201, v201, v201 row_ror:2 row_mask:0xf bank_mask:0xf
    v_add_f32_dpp v202, v202, v202 row_ror:2 row_mask:0xf bank_mask:0xf
    v_add_f32_dpp v203, v203, v203 row_ror:2 row_mask:0xf bank_mask:0xf
    v_add_f32_dpp v200, v200, v200 row_ror:1 row_mask:0xf bank_mask:0xf
    v_add_f32_dpp v201, v201, v201 row_ror:1 row_mask:0xf bank_mask:0xf
    v_add_f32_dpp v202, v202, v202 row_ror:1 row_mask:0xf bank_mask:0xf
    v_add_f32_dpp v203, v203, v203 row_ror:1 row_mask:0xf bank_mask:0xf
    buffer_load_dwordx4 v[156:159], v9, s[56:59], s86 offen nt
    s_add_u32 s86, s86, 4096
    v_accvgpr_read_b32 v224, a192
    v_accvgpr_read_b32 v225, a193
    v_accvgpr_read_b32 v226, a194
    v_accvgpr_read_b32 v227, a195
    v_accvgpr_read_b32 v228, a196
    v_accvgpr_read_b32 v229, a197
    v_accvgpr_read_b32 v230, a198
    v_accvgpr_read_b32 v231, a199
    v_accvgpr_read_b32 v232, a200
    v_accvgpr_read_b32 v233, a201
    v_accvgpr_read_b32 v234, a202
    v_accvgpr_read_b32 v235, a203
    v_accvgpr_read_b32 v236, a204
    v_accvgpr_read_b32 v237, a205
    v_accvgpr_read_b32 v238, a206
    v_accvgpr_read_b32 v239, a207
    v_dot2_f32_bf16 v208, v224, v240, 0
    v_dot2_f32_bf16 v209, v228, v240, 0
    v_dot2_f32_bf16 v210, v232, v240, 0
    v_dot2_f32_bf16 v211, v236, v240, 0
    v_dot2c_f32_bf16 v208, v225, v241
    v_dot2c_f32_bf16 v209, v229, v241
    v_dot2c_f32_bf16 v210, v233, v241
    v_dot2c_f32_bf16 v211, v237, v241
    v_dot2c_f32_bf16 v208, v226, v242
    v_dot2c_f32_bf16 v209, v230, v242
    v_dot2c_f32_bf16 v210, v234, v242
    v_dot2c_f32_bf16 v211, v238, v242
    v_dot2c_f32_bf16 v208, v227, v243
    v_dot2c_f32_bf16 v209, v231, v243
    v_dot2c_f32_bf16 v210, v235, v243
    v_dot2c_f32_bf16 v211, v239, v243
    v_add_f32_dpp v204, v204, v204 row_ror:8 row_mask:0xf bank_mask:0xf
    v_add_f32_dpp v205, v205, v205 row_ror:8 row_mask:0xf bank_mask:0xf
    v_add_f32_dpp v206, v206, v206 row_ror:8 row_mask:0xf bank_mask:0xf
    v_add_f32_dpp v207, v207, v207 row_ror:8 row_mask:0xf bank_mask:0xf
    v_add_f32_dpp v204, v204, v204 row_ror:4 row_mask:0xf bank_mask:0xf
    v_add_f32_dpp v205, v205, v205 row_ror:4 row_mask:0xf bank_mask:0xf
    v_add_f32_dpp v206, v206, v206 row_ror:4 row_mask:0xf bank_mask:0xf
    v_add_f32_dpp v207, v207, v207 row_ror:4 row_mask:0xf bank_mask:0xf
    v_add_f32_dpp v204, v204, v204 row_ror:2 row_mask:0xf bank_mask:0xf
    v_add_f32_dpp v205, v205, v205 row_ror:2 row_mask:0xf bank_mask:0xf
    v_add_f32_dpp v206, v206, v206 row_ror:2 row_mask:0xf bank_mask:0xf
    v_add_f32_dpp v207, v207, v207 row_ror:2 row_mask:0xf bank_mask:0xf
    v_add_f32_dpp v204, v204, v204 row_ror:1 row_mask:0xf bank_mask:0xf
    v_add_f32_dpp v205, v205, v205 row_ror:1 row_mask:0xf bank_mask:0xf
    v_add_f32_dpp v206, v206, v206 row_ror:1 row_mask:0xf bank_mask:0xf
    v_add_f32_dpp v207, v207, v207 row_ror:1 row_mask:0xf bank_mask:0xf
    v_accvgpr_read_b32 v224, a208
    v_accvgpr_read_b32 v225, a209
    v_accvgpr_read_b32 v226, a210
    v_accvgpr_read_b32 v227, a211
    v_accvgpr_read_b32 v228, a212
    v_accvgpr_read_b32 v229, a213
    v_accvgpr_read_b32 v230, a214
    v_accvgpr_read_b32 v231, a215
    v_accvgpr_read_b32 v232, a216
    v_accvgpr_read_b32 v233, a217
    v_accvgpr_read_b32 v234, a218
    v_accvgpr_read_b32 v235, a219
    v_accvgpr_read_b32 v236, a220
    v_accvgpr_read_b32 v237, a221
    v_accvgpr_read_b32 v238, a222
    v_accvgpr_read_b32 v239, a223
    v_dot2_f32_bf16 v212, v224, v240, 0
    v_dot2_f32_bf16 v213, v228, v240, 0
    v_dot2_f32_bf16 v214, v232, v240, 0
    v_dot2_f32_bf16 v215, v236, v240, 0
    v_dot2c_f32_bf16 v212, v225, v241
    v_dot2c_f32_bf16 v213, v229, v241
    v_dot2c_f32_bf16 v214, v233, v241
    v_dot2c_f32_bf16 v215, v237, v241
    v_dot2c_f32_bf16 v212, v226, v242
    v_dot2c_f32_bf16 v213, v230, v242
    v_dot2c_f32_bf16 v214, v234, v242
    v_dot2c_f32_bf16 v215, v238, v242
    v_dot2c_f32_bf16 v212, v227, v243
    v_dot2c_f32_bf16 v213, v231, v243
    v_dot2c_f32_bf16 v214, v235, v243
    v_dot2c_f32_bf16 v215, v239, v243
    v_add_f32_dpp v208, v208, v208 row_ror:8 row_mask:0xf bank_mask:0xf
    v_add_f32_dpp v209, v209, v209 row_ror:8 row_mask:0xf bank_mask:0xf
    v_add_f32_dpp v210, v210, v210 row_ror:8 row_mask:0xf bank_mask:0xf
    v_add_f32_dpp v211, v211, v211 row_ror:8 row_mask:0xf bank_mask:0xf
    v_add_f32_dpp v208, v208, v208 row_ror:4 row_mask:0xf bank_mask:0xf
    v_add_f32_dpp v209, v209, v209 row_ror:4 row_mask:0xf bank_mask:0xf
    v_add_f32_dpp v210, v210, v210 row_ror:4 row_mask:0xf bank_mask:0xf
    v_add_f32_dpp v211, v211, v211 row_ror:4 row_mask:0xf bank_mask:0xf
    v_add_f32_dpp v208, v208, v208 row_ror:2 row_mask:0xf bank_mask:0xf
    v_add_f32_dpp v209, v209, v209 row_ror:2 row_mask:0xf bank_mask:0xf
    v_add_f32_dpp v210, v210, v210 row_ror:2 row_mask:0xf bank_mask:0xf
    v_add_f32_dpp v211, v211, v211 row_ror:2 row_mask:0xf bank_mask:0xf
    v_add_f32_dpp v208, v208, v208 row_ror:1 row_mask:0xf bank_mask:0xf
    v_add_f32_dpp v209, v209, v209 row_ror:1 row_mask:0xf bank_mask:0xf
    v_add_f32_dpp v210, v210, v210 row_ror:1 row_mask:0xf bank_mask:0xf
    v_add_f32_dpp v211, v211, v211 row_ror:1 row_mask:0xf bank_mask:0xf
    v_accvgpr_read_b32 v224, a224
    v_accvgpr_read_b32 v225, a225
    v_accvgpr_read_b32 v226, a226
    v_accvgpr_read_b32 v227, a227
    v_accvgpr_read_b32 v228, a228
    v_accvgpr_read_b32 v229, a229
    v_accvgpr_read_b32 v230, a230
    v_accvgpr_read_b32 v231, a231
    v_accvgpr_read_b32 v232, a232
    v_accvgpr_read_b32 v233, a233
    v_accvgpr_read_b32 v234, a234
    v_accvgpr_read_b32 v235, a235
    v_accvgpr_read_b32 v236, a236
    v_accvgpr_read_b32 v237, a237
    v_accvgpr_read_b32 v238, a238
    v_accvgpr_read_b32 v239, a239
    v_dot2_f32_bf16 v216, v224, v240, 0
    v_dot2_f32_bf16 v217, v228, v240, 0
    v_dot2_f32_bf16 v218, v232, v240, 0
    v_dot2_f32_bf16 v219, v236, v240, 0
    v_dot2c_f32_bf16 v216, v225, v241
    v_dot2c_f32_bf16 v217, v229, v241
    v_dot2c_f32_bf16 v218, v233, v241
    v_dot2c_f32_bf16 v219, v237, v241
    v_dot2c_f32_bf16 v216, v226, v242
    v_dot2c_f32_bf16 v217, v230, v242
    v_dot2c_f32_bf16 v218, v234, v242
    v_dot2c_f32_bf16 v219, v238, v242
    v_dot2c_f32_bf16 v216, v227, v243
    v_dot2c_f32_bf16 v217, v231, v243
    v_dot2c_f32_bf16 v218, v235, v243
    v_dot2c_f32_bf16 v219, v239, v243
    v_add_f32_dpp v212, v212, v212 row_ror:8 row_mask:0xf bank_mask:0xf
    v_add_f32_dpp v213, v213, v213 row_ror:8 row_mask:0xf bank_mask:0xf
    v_add_f32_dpp v214, v214, v214 row_ror:8 row_mask:0xf bank_mask:0xf
    v_add_f32_dpp v215, v215, v215 row_ror:8 row_mask:0xf bank_mask:0xf
    v_add_f32_dpp v212, v212, v212 row_ror:4 row_mask:0xf bank_mask:0xf
    v_add_f32_dpp v213, v213, v213 row_ror:4 row_mask:0xf bank_mask:0xf
    v_add_f32_dpp v214, v214, v214 row_ror:4 row_mask:0xf bank_mask:0xf
    v_add_f32_dpp v215, v215, v215 row_ror:4 row_mask:0xf bank_mask:0xf
    v_add_f32_dpp v212, v212, v212 row_ror:2 row_mask:0xf bank_mask:0xf
    v_add_f32_dpp v213, v213, v213 row_ror:2 row_mask:0xf bank_mask:0xf
    v_add_f32_dpp v214, v214, v214 row_ror:2 row_mask:0xf bank_mask:0xf
    v_add_f32_dpp v215, v215, v215 row_ror:2 row_mask:0xf bank_mask:0xf
    v_add_f32_dpp v212, v212, v212 row_ror:1 row_mask:0xf bank_mask:0xf
    v_add_f32_dpp v213, v213, v213 row_ror:1 row_mask:0xf bank_mask:0xf
    v_add_f32_dpp v214, v214, v214 row_ror:1 row_mask:0xf bank_mask:0xf
    v_add_f32_dpp v215, v215, v215 row_ror:1 row_mask:0xf bank_mask:0xf
    v_accvgpr_read_b32 v224, a240
    v_accvgpr_read_b32 v225, a241
    v_accvgpr_read_b32 v226, a242
    v_accvgpr_read_b32 v227, a243
    v_accvgpr_read_b32 v228, a244
    v_accvgpr_read_b32 v229, a245
    v_accvgpr_read_b32 v230, a246
    v_accvgpr_read_b32 v231, a247
    v_accvgpr_read_b32 v232, a248
    v_accvgpr_read_b32 v233, a249
    v_accvgpr_read_b32 v234, a250
    v_accvgpr_read_b32 v235, a251
    v_accvgpr_read_b32 v236, a252
    v_accvgpr_read_b32 v237, a253
    v_accvgpr_read_b32 v238, a254
    v_accvgpr_read_b32 v239, a255
    v_dot2_f32_bf16 v220, v224, v240, 0
    v_dot2_f32_bf16 v221, v228, v240, 0
    v_dot2_f32_bf16 v222, v232, v240, 0
    v_dot2_f32_bf16 v223, v236, v240, 0
    v_dot2c_f32_bf16 v220, v225, v241
    v_dot2c_f32_bf16 v221, v229, v241
    v_dot2c_f32_bf16 v222, v233, v241
    v_dot2c_f32_bf16 v223, v237, v241
    v_dot2c_f32_bf16 v220, v226, v242
    v_dot2c_f32_bf16 v221, v230, v242
    v_dot2c_f32_bf16 v222, v234, v242
    v_dot2c_f32_bf16 v223, v238, v242
    v_dot2c_f32_bf16 v220, v227, v243
    v_dot2c_f32_bf16 v221, v231, v243
    v_dot2c_f32_bf16 v222, v235, v243
    v_dot2c_f32_bf16 v223, v239, v243
    v_add_f32_dpp v216, v216, v216 row_ror:8 row_mask:0xf bank_mask:0xf
    v_add_f32_dpp v217, v217, v217 row_ror:8 row_mask:0xf bank_mask:0xf
    v_add_f32_dpp v218, v218, v218 row_ror:8 row_mask:0xf bank_mask:0xf
    v_add_f32_dpp v219, v219, v219 row_ror:8 row_mask:0xf bank_mask:0xf
    v_add_f32_dpp v216, v216, v216 row_ror:4 row_mask:0xf bank_mask:0xf
    v_add_f32_dpp v217, v217, v217 row_ror:4 row_mask:0xf bank_mask:0xf
    v_add_f32_dpp v218, v218, v218 row_ror:4 row_mask:0xf bank_mask:0xf
    v_add_f32_dpp v219, v219, v219 row_ror:4 row_mask:0xf bank_mask:0xf
    v_add_f32_dpp v216, v216, v216 row_ror:2 row_mask:0xf bank_mask:0xf
    v_add_f32_dpp v217, v217, v217 row_ror:2 row_mask:0xf bank_mask:0xf
    v_add_f32_dpp v218, v218, v218 row_ror:2 row_mask:0xf bank_mask:0xf
    v_add_f32_dpp v219, v219, v219 row_ror:2 row_mask:0xf bank_mask:0xf
    v_add_f32_dpp v216, v216, v216 row_ror:1 row_mask:0xf bank_mask:0xf
    v_add_f32_dpp v217, v217, v217 row_ror:1 row_mask:0xf bank_mask:0xf
    v_add_f32_dpp v218, v218, v218 row_ror:1 row_mask:0xf bank_mask:0xf
    v_add_f32_dpp v219, v219, v219 row_ror:1 row_mask:0xf bank_mask:0xf
    s_nop 2
    v_add_f32_dpp v220, v220, v220 row_ror:8 row_mask:0xf bank_mask:0xf
    v_add_f32_dpp v221, v221, v221 row_ror:8 row_mask:0xf bank_mask:0xf
    v_add_f32_dpp v222, v222, v222 row_ror:8 row_mask:0xf bank_mask:0xf
    v_add_f32_dpp v223, v223, v223 row_ror:8 row_mask:0xf bank_mask:0xf
    v_add_f32_dpp v220, v220, v220 row_ror:4 row_mask:0xf bank_mask:0xf
    v_add_f32_dpp v221, v221, v221 row_ror:4 row_mask:0xf bank_mask:0xf
    v_add_f32_dpp v222, v222, v222 row_ror:4 row_mask:0xf bank_mask:0xf
    v_add_f32_dpp v223, v223, v223 row_ror:4 row_mask:0xf bank_mask:0xf
    v_add_f32_dpp v220, v220, v220 row_ror:2 row_mask:0xf bank_mask:0xf
    v_add_f32_dpp v221, v221, v221 row_ror:2 row_mask:0xf bank_mask:0xf
    v_add_f32_dpp v222, v222, v222 row_ror:2 row_mask:0xf bank_mask:0xf
    v_add_f32_dpp v223, v223, v223 row_ror:2 row_mask:0xf bank_mask:0xf
    v_add_f32_dpp v220, v220, v220 row_ror:1 row_mask:0xf bank_mask:0xf
    v_add_f32_dpp v221, v221, v221 row_ror:1 row_mask:0xf bank_mask:0xf
    v_add_f32_dpp v222, v222, v222 row_ror:1 row_mask:0xf bank_mask:0xf
    v_add_f32_dpp v223, v223, v223 row_ror:1 row_mask:0xf bank_mask:0xf
    v_cvt_pk_bf16_f32 v24, v160, v161
    v_lshlrev_b32 v160, 16, v24
    v_and_b32 v161, s46, v24
    v_mul_f32 v160, s45, v160
    v_mul_f32 v161, s45, v161
    v_cvt_pk_bf16_f32 v24, v160, v161
    v_lshlrev_b32 v160, 16, v24
    v_and_b32 v161, s46, v24
    v_cvt_pk_bf16_f32 v24, v162, v163
    v_lshlrev_b32 v162, 16, v24
    v_and_b32 v163, s46, v24
    v_mul_f32 v162, s45, v162
    v_mul_f32 v163, s45, v163
    v_cvt_pk_bf16_f32 v24, v162, v163
    v_lshlrev_b32 v162, 16, v24
    v_and_b32 v163, s46, v24
    v_cvt_pk_bf16_f32 v24, v164, v165
    v_lshlrev_b32 v164, 16, v24
    v_and_b32 v165, s46, v24
    v_mul_f32 v164, s45, v164
    v_mul_f32 v165, s45, v165
    v_cvt_pk_bf16_f32 v24, v164, v165
    v_lshlrev_b32 v164, 16, v24
    v_and_b32 v165, s46, v24
    v_cvt_pk_bf16_f32 v24, v166, v167
    v_lshlrev_b32 v166, 16, v24
    v_and_b32 v167, s46, v24
    v_mul_f32 v166, s45, v166
    v_mul_f32 v167, s45, v167
    v_cvt_pk_bf16_f32 v24, v166, v167
    v_lshlrev_b32 v166, 16, v24
    v_and_b32 v167, s46, v24
    v_cvt_pk_bf16_f32 v24, v168, v169
    v_lshlrev_b32 v168, 16, v24
    v_and_b32 v169, s46, v24
    v_mul_f32 v168, s45, v168
    v_mul_f32 v169, s45, v169
    v_cvt_pk_bf16_f32 v24, v168, v169
    v_lshlrev_b32 v168, 16, v24
    v_and_b32 v169, s46, v24
    v_cvt_pk_bf16_f32 v24, v170, v171
    v_lshlrev_b32 v170, 16, v24
    v_and_b32 v171, s46, v24
    v_mul_f32 v170, s45, v170
    v_mul_f32 v171, s45, v171
    v_cvt_pk_bf16_f32 v24, v170, v171
    v_lshlrev_b32 v170, 16, v24
    v_and_b32 v171, s46, v24
    v_cvt_pk_bf16_f32 v24, v172, v173
    v_lshlrev_b32 v172, 16, v24
    v_and_b32 v173, s46, v24
    v_mul_f32 v172, s45, v172
    v_mul_f32 v173, s45, v173
    v_cvt_pk_bf16_f32 v24, v172, v173
    v_lshlrev_b32 v172, 16, v24
    v_and_b32 v173, s46, v24
    v_cvt_pk_bf16_f32 v24, v174, v175
    v_lshlrev_b32 v174, 16, v24
    v_and_b32 v175, s46, v24
    v_mul_f32 v174, s45, v174
    v_mul_f32 v175, s45, v175
    v_cvt_pk_bf16_f32 v24, v174, v175
    v_lshlrev_b32 v174, 16, v24
    v_and_b32 v175, s46, v24
    v_cvt_pk_bf16_f32 v24, v176, v177
    v_lshlrev_b32 v176, 16, v24
    v_and_b32 v177, s46, v24
    v_mul_f32 v176, s45, v176
    v_mul_f32 v177, s45, v177
    v_cvt_pk_bf16_f32 v24, v176, v177
    v_lshlrev_b32 v176, 16, v24
    v_and_b32 v177, s46, v24
    v_cvt_pk_bf16_f32 v24, v178, v179
    v_lshlrev_b32 v178, 16, v24
    v_and_b32 v179, s46, v24
    v_mul_f32 v178, s45, v178
    v_mul_f32 v179, s45, v179
    v_cvt_pk_bf16_f32 v24, v178, v179
    v_lshlrev_b32 v178, 16, v24
    v_and_b32 v179, s46, v24
    v_cvt_pk_bf16_f32 v24, v180, v181
    v_lshlrev_b32 v180, 16, v24
    v_and_b32 v181, s46, v24
    v_mul_f32 v180, s45, v180
    v_mul_f32 v181, s45, v181
    v_cvt_pk_bf16_f32 v24, v180, v181
    v_lshlrev_b32 v180, 16, v24
    v_and_b32 v181, s46, v24
    v_cvt_pk_bf16_f32 v24, v182, v183
    v_lshlrev_b32 v182, 16, v24
    v_and_b32 v183, s46, v24
    v_mul_f32 v182, s45, v182
    v_mul_f32 v183, s45, v183
    v_cvt_pk_bf16_f32 v24, v182, v183
    v_lshlrev_b32 v182, 16, v24
    v_and_b32 v183, s46, v24
    v_cvt_pk_bf16_f32 v24, v184, v185
    v_lshlrev_b32 v184, 16, v24
    v_and_b32 v185, s46, v24
    v_mul_f32 v184, s45, v184
    v_mul_f32 v185, s45, v185
    v_cvt_pk_bf16_f32 v24, v184, v185
    v_lshlrev_b32 v184, 16, v24
    v_and_b32 v185, s46, v24
    v_cvt_pk_bf16_f32 v24, v186, v187
    v_lshlrev_b32 v186, 16, v24
    v_and_b32 v187, s46, v24
    v_mul_f32 v186, s45, v186
    v_mul_f32 v187, s45, v187
    v_cvt_pk_bf16_f32 v24, v186, v187
    v_lshlrev_b32 v186, 16, v24
    v_and_b32 v187, s46, v24
    v_cvt_pk_bf16_f32 v24, v188, v189
    v_lshlrev_b32 v188, 16, v24
    v_and_b32 v189, s46, v24
    v_mul_f32 v188, s45, v188
    v_mul_f32 v189, s45, v189
    v_cvt_pk_bf16_f32 v24, v188, v189
    v_lshlrev_b32 v188, 16, v24
    v_and_b32 v189, s46, v24
    v_cvt_pk_bf16_f32 v24, v190, v191
    v_lshlrev_b32 v190, 16, v24
    v_and_b32 v191, s46, v24
    v_mul_f32 v190, s45, v190
    v_mul_f32 v191, s45, v191
    v_cvt_pk_bf16_f32 v24, v190, v191
    v_lshlrev_b32 v190, 16, v24
    v_and_b32 v191, s46, v24
    v_cvt_pk_bf16_f32 v24, v192, v193
    v_lshlrev_b32 v192, 16, v24
    v_and_b32 v193, s46, v24
    v_mul_f32 v192, s45, v192
    v_mul_f32 v193, s45, v193
    v_cvt_pk_bf16_f32 v24, v192, v193
    v_lshlrev_b32 v192, 16, v24
    v_and_b32 v193, s46, v24
    v_cvt_pk_bf16_f32 v24, v194, v195
    v_lshlrev_b32 v194, 16, v24
    v_and_b32 v195, s46, v24
    v_mul_f32 v194, s45, v194
    v_mul_f32 v195, s45, v195
    v_cvt_pk_bf16_f32 v24, v194, v195
    v_lshlrev_b32 v194, 16, v24
    v_and_b32 v195, s46, v24
    v_cvt_pk_bf16_f32 v24, v196, v197
    v_lshlrev_b32 v196, 16, v24
    v_and_b32 v197, s46, v24
    v_mul_f32 v196, s45, v196
    v_mul_f32 v197, s45, v197
    v_cvt_pk_bf16_f32 v24, v196, v197
    v_lshlrev_b32 v196, 16, v24
    v_and_b32 v197, s46, v24
    v_cvt_pk_bf16_f32 v24, v198, v199
    v_lshlrev_b32 v198, 16, v24
    v_and_b32 v199, s46, v24
    v_mul_f32 v198, s45, v198
    v_mul_f32 v199, s45, v199
    v_cvt_pk_bf16_f32 v24, v198, v199
    v_lshlrev_b32 v198, 16, v24
    v_and_b32 v199, s46, v24
    v_cvt_pk_bf16_f32 v24, v200, v201
    v_lshlrev_b32 v200, 16, v24
    v_and_b32 v201, s46, v24
    v_mul_f32 v200, s45, v200
    v_mul_f32 v201, s45, v201
    v_cvt_pk_bf16_f32 v24, v200, v201
    v_lshlrev_b32 v200, 16, v24
    v_and_b32 v201, s46, v24
    v_cvt_pk_bf16_f32 v24, v202, v203
    v_lshlrev_b32 v202, 16, v24
    v_and_b32 v203, s46, v24
    v_mul_f32 v202, s45, v202
    v_mul_f32 v203, s45, v203
    v_cvt_pk_bf16_f32 v24, v202, v203
    v_lshlrev_b32 v202, 16, v24
    v_and_b32 v203, s46, v24
    v_cvt_pk_bf16_f32 v24, v204, v205
    v_lshlrev_b32 v204, 16, v24
    v_and_b32 v205, s46, v24
    v_mul_f32 v204, s45, v204
    v_mul_f32 v205, s45, v205
    v_cvt_pk_bf16_f32 v24, v204, v205
    v_lshlrev_b32 v204, 16, v24
    v_and_b32 v205, s46, v24
    v_cvt_pk_bf16_f32 v24, v206, v207
    v_lshlrev_b32 v206, 16, v24
    v_and_b32 v207, s46, v24
    v_mul_f32 v206, s45, v206
    v_mul_f32 v207, s45, v207
    v_cvt_pk_bf16_f32 v24, v206, v207
    v_lshlrev_b32 v206, 16, v24
    v_and_b32 v207, s46, v24
    v_cvt_pk_bf16_f32 v24, v208, v209
    v_lshlrev_b32 v208, 16, v24
    v_and_b32 v209, s46, v24
    v_mul_f32 v208, s45, v208
    v_mul_f32 v209, s45, v209
    v_cvt_pk_bf16_f32 v24, v208, v209
    v_lshlrev_b32 v208, 16, v24
    v_and_b32 v209, s46, v24
    v_cvt_pk_bf16_f32 v24, v210, v211
    v_lshlrev_b32 v210, 16, v24
    v_and_b32 v211, s46, v24
    v_mul_f32 v210, s45, v210
    v_mul_f32 v211, s45, v211
    v_cvt_pk_bf16_f32 v24, v210, v211
    v_lshlrev_b32 v210, 16, v24
    v_and_b32 v211, s46, v24
    v_cvt_pk_bf16_f32 v24, v212, v213
    v_lshlrev_b32 v212, 16, v24
    v_and_b32 v213, s46, v24
    v_mul_f32 v212, s45, v212
    v_mul_f32 v213, s45, v213
    v_cvt_pk_bf16_f32 v24, v212, v213
    v_lshlrev_b32 v212, 16, v24
    v_and_b32 v213, s46, v24
    v_cvt_pk_bf16_f32 v24, v214, v215
    v_lshlrev_b32 v214, 16, v24
    v_and_b32 v215, s46, v24
    v_mul_f32 v214, s45, v214
    v_mul_f32 v215, s45, v215
    v_cvt_pk_bf16_f32 v24, v214, v215
    v_lshlrev_b32 v214, 16, v24
    v_and_b32 v215, s46, v24
    v_cvt_pk_bf16_f32 v24, v216, v217
    v_lshlrev_b32 v216, 16, v24
    v_and_b32 v217, s46, v24
    v_mul_f32 v216, s45, v216
    v_mul_f32 v217, s45, v217
    v_cvt_pk_bf16_f32 v24, v216, v217
    v_lshlrev_b32 v216, 16, v24
    v_and_b32 v217, s46, v24
    v_cvt_pk_bf16_f32 v24, v218, v219
    v_lshlrev_b32 v218, 16, v24
    v_and_b32 v219, s46, v24
    v_mul_f32 v218, s45, v218
    v_mul_f32 v219, s45, v219
    v_cvt_pk_bf16_f32 v24, v218, v219
    v_lshlrev_b32 v218, 16, v24
    v_and_b32 v219, s46, v24
    v_cvt_pk_bf16_f32 v24, v220, v221
    v_lshlrev_b32 v220, 16, v24
    v_and_b32 v221, s46, v24
    v_mul_f32 v220, s45, v220
    v_mul_f32 v221, s45, v221
    v_cvt_pk_bf16_f32 v24, v220, v221
    v_lshlrev_b32 v220, 16, v24
    v_and_b32 v221, s46, v24
    v_cvt_pk_bf16_f32 v24, v222, v223
    v_lshlrev_b32 v222, 16, v24
    v_and_b32 v223, s46, v24
    v_mul_f32 v222, s45, v222
    v_mul_f32 v223, s45, v223
    v_cvt_pk_bf16_f32 v24, v222, v223
    v_lshlrev_b32 v222, 16, v24
    v_and_b32 v223, s46, v24
    v_max3_f32 v24, v160, v161, v162
    v_max3_f32 v24, v24, v163, v164
    v_max3_f32 v24, v24, v165, v166
    v_max3_f32 v24, v24, v167, v168
    v_max3_f32 v24, v24, v169, v170
    v_max3_f32 v24, v24, v171, v172
    v_max3_f32 v24, v24, v173, v174
    v_max3_f32 v24, v24, v175, v176
    v_max3_f32 v24, v24, v177, v178
    v_max3_f32 v24, v24, v179, v180
    v_max3_f32 v24, v24, v181, v182
    v_max3_f32 v24, v24, v183, v184
    v_max3_f32 v24, v24, v185, v186
    v_max3_f32 v24, v24, v187, v188
    v_max3_f32 v24, v24, v189, v190
    v_max3_f32 v24, v24, v191, v192
    v_max3_f32 v24, v24, v193, v194
    v_max3_f32 v24, v24, v195, v196
    v_max3_f32 v24, v24, v197, v198
    v_max3_f32 v24, v24, v199, v200
    v_max3_f32 v24, v24, v201, v202
    v_max3_f32 v24, v24, v203, v204
    v_max3_f32 v24, v24, v205, v206
    v_max3_f32 v24, v24, v207, v208
    v_max3_f32 v24, v24, v209, v210
    v_max3_f32 v24, v24, v211, v212
    v_max3_f32 v24, v24, v213, v214
    v_max3_f32 v24, v24, v215, v216
    v_max3_f32 v24, v24, v217, v218
    v_max3_f32 v24, v24, v219, v220
    v_max3_f32 v24, v24, v221, v222
    v_max_f32 v24, v24, v223
    v_mov_b32 v25, v24
    s_nop 1
    v_permlane16_swap_b32 v24, v25
    s_nop 1
    v_max_f32 v24, v24, v25
    v_mov_b32 v25, v24
    s_nop 1
    v_permlane32_swap_b32 v24, v25
    s_nop 1
    v_max_f32 v24, v24, v25
    v_mul_f32 v26, s47, v24
    v_sub_f32 v26, 0, v26
    v_mov_b32 v27, 0
    v_mov_b32 v16, 0
    v_mov_b32 v17, 0
    v_mov_b32 v18, 0
    v_mov_b32 v19, 0
    v_mov_b32 v20, 0
    v_mov_b32 v21, 0
    v_mov_b32 v22, 0
    v_mov_b32 v23, 0
    v_fma_f32 v160, v160, s47, v26
    v_exp_f32 v160, v160
    v_fma_f32 v161, v161, s47, v26
    v_exp_f32 v161, v161
    v_fma_f32 v162, v162, s47, v26
    v_exp_f32 v162, v162
    v_fma_f32 v163, v163, s47, v26
    v_exp_f32 v163, v163
    v_fma_f32 v164, v164, s47, v26
    v_exp_f32 v164, v164
    v_fma_f32 v165, v165, s47, v26
    v_exp_f32 v165, v165
    v_fma_f32 v166, v166, s47, v26
    v_exp_f32 v166, v166
    v_fma_f32 v167, v167, s47, v26
    v_exp_f32 v167, v167
    v_fma_f32 v168, v168, s47, v26
    v_exp_f32 v168, v168
    v_fma_f32 v169, v169, s47, v26
    v_exp_f32 v169, v169
    v_fma_f32 v170, v170, s47, v26
    v_exp_f32 v170, v170
    v_fma_f32 v171, v171, s47, v26
    v_exp_f32 v171, v171
    v_fma_f32 v172, v172, s47, v26
    v_exp_f32 v172, v172
    v_fma_f32 v173, v173, s47, v26
    v_exp_f32 v173, v173
    v_fma_f32 v174, v174, s47, v26
    v_exp_f32 v174, v174
    v_fma_f32 v175, v175, s47, v26
    v_exp_f32 v175, v175
    v_fma_f32 v176, v176, s47, v26
    v_exp_f32 v176, v176
    v_fma_f32 v177, v177, s47, v26
    v_exp_f32 v177, v177
    v_fma_f32 v178, v178, s47, v26
    v_exp_f32 v178, v178
    v_fma_f32 v179, v179, s47, v26
    v_exp_f32 v179, v179
    v_fma_f32 v180, v180, s47, v26
    v_exp_f32 v180, v180
    v_fma_f32 v181, v181, s47, v26
    v_exp_f32 v181, v181
    v_fma_f32 v182, v182, s47, v26
    v_exp_f32 v182, v182
    v_fma_f32 v183, v183, s47, v26
    v_exp_f32 v183, v183
    v_fma_f32 v184, v184, s47, v26
    v_exp_f32 v184, v184
    v_fma_f32 v185, v185, s47, v26
    v_exp_f32 v185, v185
    v_fma_f32 v186, v186, s47, v26
    v_exp_f32 v186, v186
    v_fma_f32 v187, v187, s47, v26
    v_exp_f32 v187, v187
    v_fma_f32 v188, v188, s47, v26
    v_exp_f32 v188, v188
    v_fma_f32 v189, v189, s47, v26
    v_exp_f32 v189, v189
    v_fma_f32 v190, v190, s47, v26
    v_exp_f32 v190, v190
    v_fma_f32 v191, v191, s47, v26
    v_exp_f32 v191, v191
    v_fma_f32 v192, v192, s47, v26
    v_exp_f32 v192, v192
    v_fma_f32 v193, v193, s47, v26
    v_exp_f32 v193, v193
    v_fma_f32 v194, v194, s47, v26
    v_exp_f32 v194, v194
    v_fma_f32 v195, v195, s47, v26
    v_exp_f32 v195, v195
    v_fma_f32 v196, v196, s47, v26
    v_exp_f32 v196, v196
    v_fma_f32 v197, v197, s47, v26
    v_exp_f32 v197, v197
    v_fma_f32 v198, v198, s47, v26
    v_exp_f32 v198, v198
    v_fma_f32 v199, v199, s47, v26
    v_exp_f32 v199, v199
    v_fma_f32 v200, v200, s47, v26
    v_exp_f32 v200, v200
    v_fma_f32 v201, v201, s47, v26
    v_exp_f32 v201, v201
    v_fma_f32 v202, v202, s47, v26
    v_exp_f32 v202, v202
    v_fma_f32 v203, v203, s47, v26
    v_exp_f32 v203, v203
    v_fma_f32 v204, v204, s47, v26
    v_exp_f32 v204, v204
    v_fma_f32 v205, v205, s47, v26
    v_exp_f32 v205, v205
    v_fma_f32 v206, v206, s47, v26
    v_exp_f32 v206, v206
    v_fma_f32 v207, v207, s47, v26
    v_exp_f32 v207, v207
    v_fma_f32 v208, v208, s47, v26
    v_exp_f32 v208, v208
    v_fma_f32 v209, v209, s47, v26
    v_exp_f32 v209, v209
    v_fma_f32 v210, v210, s47, v26
    v_exp_f32 v210, v210
    v_fma_f32 v211, v211, s47, v26
    v_exp_f32 v211, v211
    v_fma_f32 v212, v212, s47, v26
    v_exp_f32 v212, v212
    v_fma_f32 v213, v213, s47, v26
    v_exp_f32 v213, v213
    v_fma_f32 v214, v214, s47, v26
    v_exp_f32 v214, v214
    v_fma_f32 v215, v215, s47, v26
    v_exp_f32 v215, v215
    v_fma_f32 v216, v216, s47, v26
    v_exp_f32 v216, v216
    v_fma_f32 v217, v217, s47, v26
    v_exp_f32 v217, v217
    v_fma_f32 v218, v218, s47, v26
    v_exp_f32 v218, v218
    v_fma_f32 v219, v219, s47, v26
    v_exp_f32 v219, v219
    v_fma_f32 v220, v220, s47, v26
    v_exp_f32 v220, v220
    v_fma_f32 v221, v221, s47, v26
    v_exp_f32 v221, v221
    v_fma_f32 v222, v222, s47, v26
    v_exp_f32 v222, v222
    v_fma_f32 v223, v223, s47, v26
    v_exp_f32 v223, v223
    s_waitcnt vmcnt(31)
    v_add_f32 v27, v27, v160
    v_cvt_pk_bf16_f32 v28, v160, 0
    v_cvt_pk_bf16_f32 v29, 0, v160
    v_dot2c_f32_bf16 v16, v32, v28
    v_dot2c_f32_bf16 v17, v32, v29
    v_dot2c_f32_bf16 v18, v33, v28
    v_dot2c_f32_bf16 v19, v33, v29
    v_dot2c_f32_bf16 v20, v34, v28
    v_dot2c_f32_bf16 v21, v34, v29
    v_dot2c_f32_bf16 v22, v35, v28
    v_dot2c_f32_bf16 v23, v35, v29
    buffer_load_dwordx4 v[32:35], v9, s[56:59], s86 offen nt
    s_add_u32 s86, s86, 4096
    s_waitcnt vmcnt(31)
    v_add_f32 v27, v27, v161
    v_cvt_pk_bf16_f32 v30, v161, 0
    v_cvt_pk_bf16_f32 v31, 0, v161
    v_dot2c_f32_bf16 v16, v36, v30
    v_dot2c_f32_bf16 v17, v36, v31
    v_dot2c_f32_bf16 v18, v37, v30
    v_dot2c_f32_bf16 v19, v37, v31
    v_dot2c_f32_bf16 v20, v38, v30
    v_dot2c_f32_bf16 v21, v38, v31
    v_dot2c_f32_bf16 v22, v39, v30
    v_dot2c_f32_bf16 v23, v39, v31
    buffer_load_dwordx4 v[36:39], v9, s[56:59], s86 offen nt
    s_add_u32 s86, s86, 4096
    s_waitcnt vmcnt(31)
    v_add_f32 v27, v27, v162
    v_cvt_pk_bf16_f32 v28, v162, 0
    v_cvt_pk_bf16_f32 v29, 0, v162
    v_dot2c_f32_bf16 v16, v40, v28
    v_dot2c_f32_bf16 v17, v40, v29
    v_dot2c_f32_bf16 v18, v41, v28
    v_dot2c_f32_bf16 v19, v41, v29
    v_dot2c_f32_bf16 v20, v42, v28
    v_dot2c_f32_bf16 v21, v42, v29
    v_dot2c_f32_bf16 v22, v43, v28
    v_dot2c_f32_bf16 v23, v43, v29
    buffer_load_dwordx4 v[40:43], v9, s[56:59], s86 offen nt
    s_add_u32 s86, s86, 4096
    s_waitcnt vmcnt(31)
    v_add_f32 v27, v27, v163
    v_cvt_pk_bf16_f32 v30, v163, 0
    v_cvt_pk_bf16_f32 v31, 0, v163
    v_dot2c_f32_bf16 v16, v44, v30
    v_dot2c_f32_bf16 v17, v44, v31
    v_dot2c_f32_bf16 v18, v45, v30
    v_dot2c_f32_bf16 v19, v45, v31
    v_dot2c_f32_bf16 v20, v46, v30
    v_dot2c_f32_bf16 v21, v46, v31
    v_dot2c_f32_bf16 v22, v47, v30
    v_dot2c_f32_bf16 v23, v47, v31
    buffer_load_dwordx4 v[44:47], v9, s[56:59], s86 offen nt
    s_add_u32 s86, s86, 4096
    s_waitcnt vmcnt(31)
    v_add_f32 v27, v27, v164
    v_cvt_pk_bf16_f32 v28, v164, 0
    v_cvt_pk_bf16_f32 v29, 0, v164
    v_dot2c_f32_bf16 v16, v48, v28
    v_dot2c_f32_bf16 v17, v48, v29
    v_dot2c_f32_bf16 v18, v49, v28
    v_dot2c_f32_bf16 v19, v49, v29
    v_dot2c_f32_bf16 v20, v50, v28
    v_dot2c_f32_bf16 v21, v50, v29
    v_dot2c_f32_bf16 v22, v51, v28
    v_dot2c_f32_bf16 v23, v51, v29
    buffer_load_dwordx4 v[48:51], v9, s[56:59], s86 offen nt
    s_add_u32 s86, s86, 4096
    s_waitcnt vmcnt(31)
    v_add_f32 v27, v27, v165
    v_cvt_pk_bf16_f32 v30, v165, 0
    v_cvt_pk_bf16_f32 v31, 0, v165
    v_dot2c_f32_bf16 v16, v52, v30
    v_dot2c_f32_bf16 v17, v52, v31
    v_dot2c_f32_bf16 v18, v53, v30
    v_dot2c_f32_bf16 v19, v53, v31
    v_dot2c_f32_bf16 v20, v54, v30
    v_dot2c_f32_bf16 v21, v54, v31
    v_dot2c_f32_bf16 v22, v55, v30
    v_dot2c_f32_bf16 v23, v55, v31
    buffer_load_dwordx4 v[52:55], v9, s[56:59], s86 offen nt
    s_add_u32 s86, s86, 4096
    s_waitcnt vmcnt(31)
    v_add_f32 v27, v27, v166
    v_cvt_pk_bf16_f32 v28, v166, 0
    v_cvt_pk_bf16_f32 v29, 0, v166
    v_dot2c_f32_bf16 v16, v56, v28
    v_dot2c_f32_bf16 v17, v56, v29
    v_dot2c_f32_bf16 v18, v57, v28
    v_dot2c_f32_bf16 v19, v57, v29
    v_dot2c_f32_bf16 v20, v58, v28
    v_dot2c_f32_bf16 v21, v58, v29
    v_dot2c_f32_bf16 v22, v59, v28
    v_dot2c_f32_bf16 v23, v59, v29
    buffer_load_dwordx4 v[56:59], v9, s[56:59], s86 offen nt
    s_add_u32 s86, s86, 4096
    s_waitcnt vmcnt(31)
    v_add_f32 v27, v27, v167
    v_cvt_pk_bf16_f32 v30, v167, 0
    v_cvt_pk_bf16_f32 v31, 0, v167
    v_dot2c_f32_bf16 v16, v60, v30
    v_dot2c_f32_bf16 v17, v60, v31
    v_dot2c_f32_bf16 v18, v61, v30
    v_dot2c_f32_bf16 v19, v61, v31
    v_dot2c_f32_bf16 v20, v62, v30
    v_dot2c_f32_bf16 v21, v62, v31
    v_dot2c_f32_bf16 v22, v63, v30
    v_dot2c_f32_bf16 v23, v63, v31
    buffer_load_dwordx4 v[60:63], v9, s[56:59], s86 offen nt
    s_add_u32 s86, s86, 4096
    s_waitcnt vmcnt(31)
    v_add_f32 v27, v27, v168
    v_cvt_pk_bf16_f32 v28, v168, 0
    v_cvt_pk_bf16_f32 v29, 0, v168
    v_dot2c_f32_bf16 v16, v64, v28
    v_dot2c_f32_bf16 v17, v64, v29
    v_dot2c_f32_bf16 v18, v65, v28
    v_dot2c_f32_bf16 v19, v65, v29
    v_dot2c_f32_bf16 v20, v66, v28
    v_dot2c_f32_bf16 v21, v66, v29
    v_dot2c_f32_bf16 v22, v67, v28
    v_dot2c_f32_bf16 v23, v67, v29
    buffer_load_dwordx4 v[64:67], v9, s[56:59], s86 offen nt
    s_add_u32 s86, s86, 4096
    s_waitcnt vmcnt(31)
    v_add_f32 v27, v27, v169
    v_cvt_pk_bf16_f32 v30, v169, 0
    v_cvt_pk_bf16_f32 v31, 0, v169
    v_dot2c_f32_bf16 v16, v68, v30
    v_dot2c_f32_bf16 v17, v68, v31
    v_dot2c_f32_bf16 v18, v69, v30
    v_dot2c_f32_bf16 v19, v69, v31
    v_dot2c_f32_bf16 v20, v70, v30
    v_dot2c_f32_bf16 v21, v70, v31
    v_dot2c_f32_bf16 v22, v71, v30
    v_dot2c_f32_bf16 v23, v71, v31
    buffer_load_dwordx4 v[68:71], v9, s[56:59], s86 offen nt
    s_add_u32 s86, s86, 4096
    s_waitcnt vmcnt(31)
    v_add_f32 v27, v27, v170
    v_cvt_pk_bf16_f32 v28, v170, 0
    v_cvt_pk_bf16_f32 v29, 0, v170
    v_dot2c_f32_bf16 v16, v72, v28
    v_dot2c_f32_bf16 v17, v72, v29
    v_dot2c_f32_bf16 v18, v73, v28
    v_dot2c_f32_bf16 v19, v73, v29
    v_dot2c_f32_bf16 v20, v74, v28
    v_dot2c_f32_bf16 v21, v74, v29
    v_dot2c_f32_bf16 v22, v75, v28
    v_dot2c_f32_bf16 v23, v75, v29
    buffer_load_dwordx4 v[72:75], v9, s[56:59], s86 offen nt
    s_add_u32 s86, s86, 4096
    s_waitcnt vmcnt(31)
    v_add_f32 v27, v27, v171
    v_cvt_pk_bf16_f32 v30, v171, 0
    v_cvt_pk_bf16_f32 v31, 0, v171
    v_dot2c_f32_bf16 v16, v76, v30
    v_dot2c_f32_bf16 v17, v76, v31
    v_dot2c_f32_bf16 v18, v77, v30
    v_dot2c_f32_bf16 v19, v77, v31
    v_dot2c_f32_bf16 v20, v78, v30
    v_dot2c_f32_bf16 v21, v78, v31
    v_dot2c_f32_bf16 v22, v79, v30
    v_dot2c_f32_bf16 v23, v79, v31
    buffer_load_dwordx4 v[76:79], v9, s[56:59], s86 offen nt
    s_add_u32 s86, s86, 4096
    s_waitcnt vmcnt(31)
    v_add_f32 v27, v27, v172
    v_cvt_pk_bf16_f32 v28, v172, 0
    v_cvt_pk_bf16_f32 v29, 0, v172
    v_dot2c_f32_bf16 v16, v80, v28
    v_dot2c_f32_bf16 v17, v80, v29
    v_dot2c_f32_bf16 v18, v81, v28
    v_dot2c_f32_bf16 v19, v81, v29
    v_dot2c_f32_bf16 v20, v82, v28
    v_dot2c_f32_bf16 v21, v82, v29
    v_dot2c_f32_bf16 v22, v83, v28
    v_dot2c_f32_bf16 v23, v83, v29
    buffer_load_dwordx4 v[80:83], v9, s[56:59], s86 offen nt
    s_add_u32 s86, s86, 4096
    s_waitcnt vmcnt(31)
    v_add_f32 v27, v27, v173
    v_cvt_pk_bf16_f32 v30, v173, 0
    v_cvt_pk_bf16_f32 v31, 0, v173
    v_dot2c_f32_bf16 v16, v84, v30
    v_dot2c_f32_bf16 v17, v84, v31
    v_dot2c_f32_bf16 v18, v85, v30
    v_dot2c_f32_bf16 v19, v85, v31
    v_dot2c_f32_bf16 v20, v86, v30
    v_dot2c_f32_bf16 v21, v86, v31
    v_dot2c_f32_bf16 v22, v87, v30
    v_dot2c_f32_bf16 v23, v87, v31
    buffer_load_dwordx4 v[84:87], v9, s[56:59], s86 offen nt
    s_add_u32 s86, s86, 4096
    s_waitcnt vmcnt(31)
    v_add_f32 v27, v27, v174
    v_cvt_pk_bf16_f32 v28, v174, 0
    v_cvt_pk_bf16_f32 v29, 0, v174
    v_dot2c_f32_bf16 v16, v88, v28
    v_dot2c_f32_bf16 v17, v88, v29
    v_dot2c_f32_bf16 v18, v89, v28
    v_dot2c_f32_bf16 v19, v89, v29
    v_dot2c_f32_bf16 v20, v90, v28
    v_dot2c_f32_bf16 v21, v90, v29
    v_dot2c_f32_bf16 v22, v91, v28
    v_dot2c_f32_bf16 v23, v91, v29
    buffer_load_dwordx4 v[88:91], v9, s[56:59], s86 offen nt
    s_add_u32 s86, s86, 4096
    s_waitcnt vmcnt(31)
    v_add_f32 v27, v27, v175
    v_cvt_pk_bf16_f32 v30, v175, 0
    v_cvt_pk_bf16_f32 v31, 0, v175
    v_dot2c_f32_bf16 v16, v92, v30
    v_dot2c_f32_bf16 v17, v92, v31
    v_dot2c_f32_bf16 v18, v93, v30
    v_dot2c_f32_bf16 v19, v93, v31
    v_dot2c_f32_bf16 v20, v94, v30
    v_dot2c_f32_bf16 v21, v94, v31
    v_dot2c_f32_bf16 v22, v95, v30
    v_dot2c_f32_bf16 v23, v95, v31
    buffer_load_dwordx4 v[92:95], v9, s[56:59], s86 offen nt
    s_add_u32 s86, s86, 4096
    s_waitcnt vmcnt(31)
    v_add_f32 v27, v27, v176
    v_cvt_pk_bf16_f32 v28, v176, 0
    v_cvt_pk_bf16_f32 v29, 0, v176
    v_dot2c_f32_bf16 v16, v96, v28
    v_dot2c_f32_bf16 v17, v96, v29
    v_dot2c_f32_bf16 v18, v97, v28
    v_dot2c_f32_bf16 v19, v97, v29
    v_dot2c_f32_bf16 v20, v98, v28
    v_dot2c_f32_bf16 v21, v98, v29
    v_dot2c_f32_bf16 v22, v99, v28
    v_dot2c_f32_bf16 v23, v99, v29
    buffer_load_dwordx4 v[96:99], v9, s[56:59], s86 offen nt
    s_add_u32 s86, s86, 4096
    s_waitcnt vmcnt(31)
    v_add_f32 v27, v27, v177
    v_cvt_pk_bf16_f32 v30, v177, 0
    v_cvt_pk_bf16_f32 v31, 0, v177
    v_dot2c_f32_bf16 v16, v100, v30
    v_dot2c_f32_bf16 v17, v100, v31
    v_dot2c_f32_bf16 v18, v101, v30
    v_dot2c_f32_bf16 v19, v101, v31
    v_dot2c_f32_bf16 v20, v102, v30
    v_dot2c_f32_bf16 v21, v102, v31
    v_dot2c_f32_bf16 v22, v103, v30
    v_dot2c_f32_bf16 v23, v103, v31
    buffer_load_dwordx4 v[100:103], v9, s[56:59], s86 offen nt
    s_add_u32 s86, s86, 4096
    s_waitcnt vmcnt(31)
    v_add_f32 v27, v27, v178
    v_cvt_pk_bf16_f32 v28, v178, 0
    v_cvt_pk_bf16_f32 v29, 0, v178
    v_dot2c_f32_bf16 v16, v104, v28
    v_dot2c_f32_bf16 v17, v104, v29
    v_dot2c_f32_bf16 v18, v105, v28
    v_dot2c_f32_bf16 v19, v105, v29
    v_dot2c_f32_bf16 v20, v106, v28
    v_dot2c_f32_bf16 v21, v106, v29
    v_dot2c_f32_bf16 v22, v107, v28
    v_dot2c_f32_bf16 v23, v107, v29
    buffer_load_dwordx4 v[104:107], v9, s[56:59], s86 offen nt
    s_add_u32 s86, s86, 4096
    s_waitcnt vmcnt(31)
    v_add_f32 v27, v27, v179
    v_cvt_pk_bf16_f32 v30, v179, 0
    v_cvt_pk_bf16_f32 v31, 0, v179
    v_dot2c_f32_bf16 v16, v108, v30
    v_dot2c_f32_bf16 v17, v108, v31
    v_dot2c_f32_bf16 v18, v109, v30
    v_dot2c_f32_bf16 v19, v109, v31
    v_dot2c_f32_bf16 v20, v110, v30
    v_dot2c_f32_bf16 v21, v110, v31
    v_dot2c_f32_bf16 v22, v111, v30
    v_dot2c_f32_bf16 v23, v111, v31
    buffer_load_dwordx4 v[108:111], v9, s[56:59], s86 offen nt
    s_add_u32 s86, s86, 4096
    s_waitcnt vmcnt(31)
    v_add_f32 v27, v27, v180
    v_cvt_pk_bf16_f32 v28, v180, 0
    v_cvt_pk_bf16_f32 v29, 0, v180
    v_dot2c_f32_bf16 v16, v112, v28
    v_dot2c_f32_bf16 v17, v112, v29
    v_dot2c_f32_bf16 v18, v113, v28
    v_dot2c_f32_bf16 v19, v113, v29
    v_dot2c_f32_bf16 v20, v114, v28
    v_dot2c_f32_bf16 v21, v114, v29
    v_dot2c_f32_bf16 v22, v115, v28
    v_dot2c_f32_bf16 v23, v115, v29
    buffer_load_dwordx4 v[112:115], v9, s[56:59], s86 offen nt
    s_add_u32 s86, s86, 4096
    s_waitcnt vmcnt(31)
    v_add_f32 v27, v27, v181
    v_cvt_pk_bf16_f32 v30, v181, 0
    v_cvt_pk_bf16_f32 v31, 0, v181
    v_dot2c_f32_bf16 v16, v116, v30
    v_dot2c_f32_bf16 v17, v116, v31
    v_dot2c_f32_bf16 v18, v117, v30
    v_dot2c_f32_bf16 v19, v117, v31
    v_dot2c_f32_bf16 v20, v118, v30
    v_dot2c_f32_bf16 v21, v118, v31
    v_dot2c_f32_bf16 v22, v119, v30
    v_dot2c_f32_bf16 v23, v119, v31
    buffer_load_dwordx4 v[116:119], v9, s[56:59], s86 offen nt
    s_add_u32 s86, s86, 4096
    s_waitcnt vmcnt(31)
    v_add_f32 v27, v27, v182
    v_cvt_pk_bf16_f32 v28, v182, 0
    v_cvt_pk_bf16_f32 v29, 0, v182
    v_dot2c_f32_bf16 v16, v120, v28
    v_dot2c_f32_bf16 v17, v120, v29
    v_dot2c_f32_bf16 v18, v121, v28
    v_dot2c_f32_bf16 v19, v121, v29
    v_dot2c_f32_bf16 v20, v122, v28
    v_dot2c_f32_bf16 v21, v122, v29
    v_dot2c_f32_bf16 v22, v123, v28
    v_dot2c_f32_bf16 v23, v123, v29
    buffer_load_dwordx4 v[120:123], v9, s[56:59], s86 offen nt
    s_add_u32 s86, s86, 4096
    s_waitcnt vmcnt(31)
    v_add_f32 v27, v27, v183
    v_cvt_pk_bf16_f32 v30, v183, 0
    v_cvt_pk_bf16_f32 v31, 0, v183
    v_dot2c_f32_bf16 v16, v124, v30
    v_dot2c_f32_bf16 v17, v124, v31
    v_dot2c_f32_bf16 v18, v125, v30
    v_dot2c_f32_bf16 v19, v125, v31
    v_dot2c_f32_bf16 v20, v126, v30
    v_dot2c_f32_bf16 v21, v126, v31
    v_dot2c_f32_bf16 v22, v127, v30
    v_dot2c_f32_bf16 v23, v127, v31
    buffer_load_dwordx4 v[124:127], v9, s[56:59], s86 offen nt
    s_add_u32 s86, s86, 4096
    s_waitcnt vmcnt(31)
    v_add_f32 v27, v27, v184
    v_cvt_pk_bf16_f32 v28, v184, 0
    v_cvt_pk_bf16_f32 v29, 0, v184
    v_dot2c_f32_bf16 v16, v128, v28
    v_dot2c_f32_bf16 v17, v128, v29
    v_dot2c_f32_bf16 v18, v129, v28
    v_dot2c_f32_bf16 v19, v129, v29
    v_dot2c_f32_bf16 v20, v130, v28
    v_dot2c_f32_bf16 v21, v130, v29
    v_dot2c_f32_bf16 v22, v131, v28
    v_dot2c_f32_bf16 v23, v131, v29
    buffer_load_dwordx4 v[128:131], v9, s[56:59], s86 offen nt
    s_add_u32 s86, s86, 4096
    s_waitcnt vmcnt(31)
    v_add_f32 v27, v27, v185
    v_cvt_pk_bf16_f32 v30, v185, 0
    v_cvt_pk_bf16_f32 v31, 0, v185
    v_dot2c_f32_bf16 v16, v132, v30
    v_dot2c_f32_bf16 v17, v132, v31
    v_dot2c_f32_bf16 v18, v133, v30
    v_dot2c_f32_bf16 v19, v133, v31
    v_dot2c_f32_bf16 v20, v134, v30
    v_dot2c_f32_bf16 v21, v134, v31
    v_dot2c_f32_bf16 v22, v135, v30
    v_dot2c_f32_bf16 v23, v135, v31
    buffer_load_dwordx4 v[132:135], v9, s[56:59], s86 offen nt
    s_add_u32 s86, s86, 4096
    s_waitcnt vmcnt(31)
    v_add_f32 v27, v27, v186
    v_cvt_pk_bf16_f32 v28, v186, 0
    v_cvt_pk_bf16_f32 v29, 0, v186
    v_dot2c_f32_bf16 v16, v136, v28
    v_dot2c_f32_bf16 v17, v136, v29
    v_dot2c_f32_bf16 v18, v137, v28
    v_dot2c_f32_bf16 v19, v137, v29
    v_dot2c_f32_bf16 v20, v138, v28
    v_dot2c_f32_bf16 v21, v138, v29
    v_dot2c_f32_bf16 v22, v139, v28
    v_dot2c_f32_bf16 v23, v139, v29
    buffer_load_dwordx4 v[136:139], v9, s[56:59], s86 offen nt
    s_add_u32 s86, s86, 4096
    s_waitcnt vmcnt(31)
    v_add_f32 v27, v27, v187
    v_cvt_pk_bf16_f32 v30, v187, 0
    v_cvt_pk_bf16_f32 v31, 0, v187
    v_dot2c_f32_bf16 v16, v140, v30
    v_dot2c_f32_bf16 v17, v140, v31
    v_dot2c_f32_bf16 v18, v141, v30
    v_dot2c_f32_bf16 v19, v141, v31
    v_dot2c_f32_bf16 v20, v142, v30
    v_dot2c_f32_bf16 v21, v142, v31
    v_dot2c_f32_bf16 v22, v143, v30
    v_dot2c_f32_bf16 v23, v143, v31
    buffer_load_dwordx4 v[140:143], v9, s[56:59], s86 offen nt
    s_add_u32 s86, s86, 4096
    s_waitcnt vmcnt(31)
    v_add_f32 v27, v27, v188
    v_cvt_pk_bf16_f32 v28, v188, 0
    v_cvt_pk_bf16_f32 v29, 0, v188
    v_dot2c_f32_bf16 v16, v144, v28
    v_dot2c_f32_bf16 v17, v144, v29
    v_dot2c_f32_bf16 v18, v145, v28
    v_dot2c_f32_bf16 v19, v145, v29
    v_dot2c_f32_bf16 v20, v146, v28
    v_dot2c_f32_bf16 v21, v146, v29
    v_dot2c_f32_bf16 v22, v147, v28
    v_dot2c_f32_bf16 v23, v147, v29
    buffer_load_dwordx4 v[144:147], v9, s[56:59], s86 offen nt
    s_add_u32 s86, s86, 4096
    s_waitcnt vmcnt(31)
    v_add_f32 v27, v27, v189
    v_cvt_pk_bf16_f32 v30, v189, 0
    v_cvt_pk_bf16_f32 v31, 0, v189
    v_dot2c_f32_bf16 v16, v148, v30
    v_dot2c_f32_bf16 v17, v148, v31
    v_dot2c_f32_bf16 v18, v149, v30
    v_dot2c_f32_bf16 v19, v149, v31
    v_dot2c_f32_bf16 v20, v150, v30
    v_dot2c_f32_bf16 v21, v150, v31
    v_dot2c_f32_bf16 v22, v151, v30
    v_dot2c_f32_bf16 v23, v151, v31
    buffer_load_dwordx4 v[148:151], v9, s[56:59], s86 offen nt
    s_add_u32 s86, s86, 4096
    s_waitcnt vmcnt(31)
    v_add_f32 v27, v27, v190
    v_cvt_pk_bf16_f32 v28, v190, 0
    v_cvt_pk_bf16_f32 v29, 0, v190
    v_dot2c_f32_bf16 v16, v152, v28
    v_dot2c_f32_bf16 v17, v152, v29
    v_dot2c_f32_bf16 v18, v153, v28
    v_dot2c_f32_bf16 v19, v153, v29
    v_dot2c_f32_bf16 v20, v154, v28
    v_dot2c_f32_bf16 v21, v154, v29
    v_dot2c_f32_bf16 v22, v155, v28
    v_dot2c_f32_bf16 v23, v155, v29
    buffer_load_dwordx4 v[152:155], v9, s[56:59], s86 offen nt
    s_add_u32 s86, s86, 4096
    s_waitcnt vmcnt(31)
    v_add_f32 v27, v27, v191
    v_cvt_pk_bf16_f32 v30, v191, 0
    v_cvt_pk_bf16_f32 v31, 0, v191
    v_dot2c_f32_bf16 v16, v156, v30
    v_dot2c_f32_bf16 v17, v156, v31
    v_dot2c_f32_bf16 v18, v157, v30
    v_dot2c_f32_bf16 v19, v157, v31
    v_dot2c_f32_bf16 v20, v158, v30
    v_dot2c_f32_bf16 v21, v158, v31
    v_dot2c_f32_bf16 v22, v159, v30
    v_dot2c_f32_bf16 v23, v159, v31
    buffer_load_dwordx4 v[156:159], v9, s[56:59], s86 offen nt
    s_add_u32 s86, s86, 4096
    s_waitcnt vmcnt(31)
    v_add_f32 v27, v27, v192
    v_cvt_pk_bf16_f32 v28, v192, 0
    v_cvt_pk_bf16_f32 v29, 0, v192
    v_dot2c_f32_bf16 v16, v32, v28
    v_dot2c_f32_bf16 v17, v32, v29
    v_dot2c_f32_bf16 v18, v33, v28
    v_dot2c_f32_bf16 v19, v33, v29
    v_dot2c_f32_bf16 v20, v34, v28
    v_dot2c_f32_bf16 v21, v34, v29
    v_dot2c_f32_bf16 v22, v35, v28
    v_dot2c_f32_bf16 v23, v35, v29
    s_waitcnt vmcnt(30)
    v_add_f32 v27, v27, v193
    v_cvt_pk_bf16_f32 v30, v193, 0
    v_cvt_pk_bf16_f32 v31, 0, v193
    v_dot2c_f32_bf16 v16, v36, v30
    v_dot2c_f32_bf16 v17, v36, v31
    v_dot2c_f32_bf16 v18, v37, v30
    v_dot2c_f32_bf16 v19, v37, v31
    v_dot2c_f32_bf16 v20, v38, v30
    v_dot2c_f32_bf16 v21, v38, v31
    v_dot2c_f32_bf16 v22, v39, v30
    v_dot2c_f32_bf16 v23, v39, v31
    s_waitcnt vmcnt(29)
    v_add_f32 v27, v27, v194
    v_cvt_pk_bf16_f32 v28, v194, 0
    v_cvt_pk_bf16_f32 v29, 0, v194
    v_dot2c_f32_bf16 v16, v40, v28
    v_dot2c_f32_bf16 v17, v40, v29
    v_dot2c_f32_bf16 v18, v41, v28
    v_dot2c_f32_bf16 v19, v41, v29
    v_dot2c_f32_bf16 v20, v42, v28
    v_dot2c_f32_bf16 v21, v42, v29
    v_dot2c_f32_bf16 v22, v43, v28
    v_dot2c_f32_bf16 v23, v43, v29
    s_waitcnt vmcnt(28)
    v_add_f32 v27, v27, v195
    v_cvt_pk_bf16_f32 v30, v195, 0
    v_cvt_pk_bf16_f32 v31, 0, v195
    v_dot2c_f32_bf16 v16, v44, v30
    v_dot2c_f32_bf16 v17, v44, v31
    v_dot2c_f32_bf16 v18, v45, v30
    v_dot2c_f32_bf16 v19, v45, v31
    v_dot2c_f32_bf16 v20, v46, v30
    v_dot2c_f32_bf16 v21, v46, v31
    v_dot2c_f32_bf16 v22, v47, v30
    v_dot2c_f32_bf16 v23, v47, v31
    s_waitcnt vmcnt(27)
    v_add_f32 v27, v27, v196
    v_cvt_pk_bf16_f32 v28, v196, 0
    v_cvt_pk_bf16_f32 v29, 0, v196
    v_dot2c_f32_bf16 v16, v48, v28
    v_dot2c_f32_bf16 v17, v48, v29
    v_dot2c_f32_bf16 v18, v49, v28
    v_dot2c_f32_bf16 v19, v49, v29
    v_dot2c_f32_bf16 v20, v50, v28
    v_dot2c_f32_bf16 v21, v50, v29
    v_dot2c_f32_bf16 v22, v51, v28
    v_dot2c_f32_bf16 v23, v51, v29
    s_waitcnt vmcnt(26)
    v_add_f32 v27, v27, v197
    v_cvt_pk_bf16_f32 v30, v197, 0
    v_cvt_pk_bf16_f32 v31, 0, v197
    v_dot2c_f32_bf16 v16, v52, v30
    v_dot2c_f32_bf16 v17, v52, v31
    v_dot2c_f32_bf16 v18, v53, v30
    v_dot2c_f32_bf16 v19, v53, v31
    v_dot2c_f32_bf16 v20, v54, v30
    v_dot2c_f32_bf16 v21, v54, v31
    v_dot2c_f32_bf16 v22, v55, v30
    v_dot2c_f32_bf16 v23, v55, v31
    s_waitcnt vmcnt(25)
    v_add_f32 v27, v27, v198
    v_cvt_pk_bf16_f32 v28, v198, 0
    v_cvt_pk_bf16_f32 v29, 0, v198
    v_dot2c_f32_bf16 v16, v56, v28
    v_dot2c_f32_bf16 v17, v56, v29
    v_dot2c_f32_bf16 v18, v57, v28
    v_dot2c_f32_bf16 v19, v57, v29
    v_dot2c_f32_bf16 v20, v58, v28
    v_dot2c_f32_bf16 v21, v58, v29
    v_dot2c_f32_bf16 v22, v59, v28
    v_dot2c_f32_bf16 v23, v59, v29
    s_waitcnt vmcnt(24)
    v_add_f32 v27, v27, v199
    v_cvt_pk_bf16_f32 v30, v199, 0
    v_cvt_pk_bf16_f32 v31, 0, v199
    v_dot2c_f32_bf16 v16, v60, v30
    v_dot2c_f32_bf16 v17, v60, v31
    v_dot2c_f32_bf16 v18, v61, v30
    v_dot2c_f32_bf16 v19, v61, v31
    v_dot2c_f32_bf16 v20, v62, v30
    v_dot2c_f32_bf16 v21, v62, v31
    v_dot2c_f32_bf16 v22, v63, v30
    v_dot2c_f32_bf16 v23, v63, v31
    s_waitcnt vmcnt(23)
    v_add_f32 v27, v27, v200
    v_cvt_pk_bf16_f32 v28, v200, 0
    v_cvt_pk_bf16_f32 v29, 0, v200
    v_dot2c_f32_bf16 v16, v64, v28
    v_dot2c_f32_bf16 v17, v64, v29
    v_dot2c_f32_bf16 v18, v65, v28
    v_dot2c_f32_bf16 v19, v65, v29
    v_dot2c_f32_bf16 v20, v66, v28
    v_dot2c_f32_bf16 v21, v66, v29
    v_dot2c_f32_bf16 v22, v67, v28
    v_dot2c_f32_bf16 v23, v67, v29
    s_waitcnt vmcnt(22)
    v_add_f32 v27, v27, v201
    v_cvt_pk_bf16_f32 v30, v201, 0
    v_cvt_pk_bf16_f32 v31, 0, v201
    v_dot2c_f32_bf16 v16, v68, v30
    v_dot2c_f32_bf16 v17, v68, v31
    v_dot2c_f32_bf16 v18, v69, v30
    v_dot2c_f32_bf16 v19, v69, v31
    v_dot2c_f32_bf16 v20, v70, v30
    v_dot2c_f32_bf16 v21, v70, v31
    v_dot2c_f32_bf16 v22, v71, v30
    v_dot2c_f32_bf16 v23, v71, v31
    s_waitcnt vmcnt(21)
    v_add_f32 v27, v27, v202
    v_cvt_pk_bf16_f32 v28, v202, 0
    v_cvt_pk_bf16_f32 v29, 0, v202
    v_dot2c_f32_bf16 v16, v72, v28
    v_dot2c_f32_bf16 v17, v72, v29
    v_dot2c_f32_bf16 v18, v73, v28
    v_dot2c_f32_bf16 v19, v73, v29
    v_dot2c_f32_bf16 v20, v74, v28
    v_dot2c_f32_bf16 v21, v74, v29
    v_dot2c_f32_bf16 v22, v75, v28
    v_dot2c_f32_bf16 v23, v75, v29
    s_waitcnt vmcnt(20)
    v_add_f32 v27, v27, v203
    v_cvt_pk_bf16_f32 v30, v203, 0
    v_cvt_pk_bf16_f32 v31, 0, v203
    v_dot2c_f32_bf16 v16, v76, v30
    v_dot2c_f32_bf16 v17, v76, v31
    v_dot2c_f32_bf16 v18, v77, v30
    v_dot2c_f32_bf16 v19, v77, v31
    v_dot2c_f32_bf16 v20, v78, v30
    v_dot2c_f32_bf16 v21, v78, v31
    v_dot2c_f32_bf16 v22, v79, v30
    v_dot2c_f32_bf16 v23, v79, v31
    s_waitcnt vmcnt(19)
    v_add_f32 v27, v27, v204
    v_cvt_pk_bf16_f32 v28, v204, 0
    v_cvt_pk_bf16_f32 v29, 0, v204
    v_dot2c_f32_bf16 v16, v80, v28
    v_dot2c_f32_bf16 v17, v80, v29
    v_dot2c_f32_bf16 v18, v81, v28
    v_dot2c_f32_bf16 v19, v81, v29
    v_dot2c_f32_bf16 v20, v82, v28
    v_dot2c_f32_bf16 v21, v82, v29
    v_dot2c_f32_bf16 v22, v83, v28
    v_dot2c_f32_bf16 v23, v83, v29
    s_waitcnt vmcnt(18)
    v_add_f32 v27, v27, v205
    v_cvt_pk_bf16_f32 v30, v205, 0
    v_cvt_pk_bf16_f32 v31, 0, v205
    v_dot2c_f32_bf16 v16, v84, v30
    v_dot2c_f32_bf16 v17, v84, v31
    v_dot2c_f32_bf16 v18, v85, v30
    v_dot2c_f32_bf16 v19, v85, v31
    v_dot2c_f32_bf16 v20, v86, v30
    v_dot2c_f32_bf16 v21, v86, v31
    v_dot2c_f32_bf16 v22, v87, v30
    v_dot2c_f32_bf16 v23, v87, v31
    s_waitcnt vmcnt(17)
    v_add_f32 v27, v27, v206
    v_cvt_pk_bf16_f32 v28, v206, 0
    v_cvt_pk_bf16_f32 v29, 0, v206
    v_dot2c_f32_bf16 v16, v88, v28
    v_dot2c_f32_bf16 v17, v88, v29
    v_dot2c_f32_bf16 v18, v89, v28
    v_dot2c_f32_bf16 v19, v89, v29
    v_dot2c_f32_bf16 v20, v90, v28
    v_dot2c_f32_bf16 v21, v90, v29
    v_dot2c_f32_bf16 v22, v91, v28
    v_dot2c_f32_bf16 v23, v91, v29
    s_waitcnt vmcnt(16)
    v_add_f32 v27, v27, v207
    v_cvt_pk_bf16_f32 v30, v207, 0
    v_cvt_pk_bf16_f32 v31, 0, v207
    v_dot2c_f32_bf16 v16, v92, v30
    v_dot2c_f32_bf16 v17, v92, v31
    v_dot2c_f32_bf16 v18, v93, v30
    v_dot2c_f32_bf16 v19, v93, v31
    v_dot2c_f32_bf16 v20, v94, v30
    v_dot2c_f32_bf16 v21, v94, v31
    v_dot2c_f32_bf16 v22, v95, v30
    v_dot2c_f32_bf16 v23, v95, v31
    s_waitcnt vmcnt(15)
    v_add_f32 v27, v27, v208
    v_cvt_pk_bf16_f32 v28, v208, 0
    v_cvt_pk_bf16_f32 v29, 0, v208
    v_dot2c_f32_bf16 v16, v96, v28
    v_dot2c_f32_bf16 v17, v96, v29
    v_dot2c_f32_bf16 v18, v97, v28
    v_dot2c_f32_bf16 v19, v97, v29
    v_dot2c_f32_bf16 v20, v98, v28
    v_dot2c_f32_bf16 v21, v98, v29
    v_dot2c_f32_bf16 v22, v99, v28
    v_dot2c_f32_bf16 v23, v99, v29
    s_waitcnt vmcnt(14)
    v_add_f32 v27, v27, v209
    v_cvt_pk_bf16_f32 v30, v209, 0
    v_cvt_pk_bf16_f32 v31, 0, v209
    v_dot2c_f32_bf16 v16, v100, v30
    v_dot2c_f32_bf16 v17, v100, v31
    v_dot2c_f32_bf16 v18, v101, v30
    v_dot2c_f32_bf16 v19, v101, v31
    v_dot2c_f32_bf16 v20, v102, v30
    v_dot2c_f32_bf16 v21, v102, v31
    v_dot2c_f32_bf16 v22, v103, v30
    v_dot2c_f32_bf16 v23, v103, v31
    s_waitcnt vmcnt(13)
    v_add_f32 v27, v27, v210
    v_cvt_pk_bf16_f32 v28, v210, 0
    v_cvt_pk_bf16_f32 v29, 0, v210
    v_dot2c_f32_bf16 v16, v104, v28
    v_dot2c_f32_bf16 v17, v104, v29
    v_dot2c_f32_bf16 v18, v105, v28
    v_dot2c_f32_bf16 v19, v105, v29
    v_dot2c_f32_bf16 v20, v106, v28
    v_dot2c_f32_bf16 v21, v106, v29
    v_dot2c_f32_bf16 v22, v107, v28
    v_dot2c_f32_bf16 v23, v107, v29
    s_waitcnt vmcnt(12)
    v_add_f32 v27, v27, v211
    v_cvt_pk_bf16_f32 v30, v211, 0
    v_cvt_pk_bf16_f32 v31, 0, v211
    v_dot2c_f32_bf16 v16, v108, v30
    v_dot2c_f32_bf16 v17, v108, v31
    v_dot2c_f32_bf16 v18, v109, v30
    v_dot2c_f32_bf16 v19, v109, v31
    v_dot2c_f32_bf16 v20, v110, v30
    v_dot2c_f32_bf16 v21, v110, v31
    v_dot2c_f32_bf16 v22, v111, v30
    v_dot2c_f32_bf16 v23, v111, v31
    s_waitcnt vmcnt(11)
    v_add_f32 v27, v27, v212
    v_cvt_pk_bf16_f32 v28, v212, 0
    v_cvt_pk_bf16_f32 v29, 0, v212
    v_dot2c_f32_bf16 v16, v112, v28
    v_dot2c_f32_bf16 v17, v112, v29
    v_dot2c_f32_bf16 v18, v113, v28
    v_dot2c_f32_bf16 v19, v113, v29
    v_dot2c_f32_bf16 v20, v114, v28
    v_dot2c_f32_bf16 v21, v114, v29
    v_dot2c_f32_bf16 v22, v115, v28
    v_dot2c_f32_bf16 v23, v115, v29
    s_waitcnt vmcnt(10)
    v_add_f32 v27, v27, v213
    v_cvt_pk_bf16_f32 v30, v213, 0
    v_cvt_pk_bf16_f32 v31, 0, v213
    v_dot2c_f32_bf16 v16, v116, v30
    v_dot2c_f32_bf16 v17, v116, v31
    v_dot2c_f32_bf16 v18, v117, v30
    v_dot2c_f32_bf16 v19, v117, v31
    v_dot2c_f32_bf16 v20, v118, v30
    v_dot2c_f32_bf16 v21, v118, v31
    v_dot2c_f32_bf16 v22, v119, v30
    v_dot2c_f32_bf16 v23, v119, v31
    s_waitcnt vmcnt(9)
    v_add_f32 v27, v27, v214
    v_cvt_pk_bf16_f32 v28, v214, 0
    v_cvt_pk_bf16_f32 v29, 0, v214
    v_dot2c_f32_bf16 v16, v120, v28
    v_dot2c_f32_bf16 v17, v120, v29
    v_dot2c_f32_bf16 v18, v121, v28
    v_dot2c_f32_bf16 v19, v121, v29
    v_dot2c_f32_bf16 v20, v122, v28
    v_dot2c_f32_bf16 v21, v122, v29
    v_dot2c_f32_bf16 v22, v123, v28
    v_dot2c_f32_bf16 v23, v123, v29
    s_waitcnt vmcnt(8)
    v_add_f32 v27, v27, v215
    v_cvt_pk_bf16_f32 v30, v215, 0
    v_cvt_pk_bf16_f32 v31, 0, v215
    v_dot2c_f32_bf16 v16, v124, v30
    v_dot2c_f32_bf16 v17, v124, v31
    v_dot2c_f32_bf16 v18, v125, v30
    v_dot2c_f32_bf16 v19, v125, v31
    v_dot2c_f32_bf16 v20, v126, v30
    v_dot2c_f32_bf16 v21, v126, v31
    v_dot2c_f32_bf16 v22, v127, v30
    v_dot2c_f32_bf16 v23, v127, v31
    s_waitcnt vmcnt(7)
    v_add_f32 v27, v27, v216
    v_cvt_pk_bf16_f32 v28, v216, 0
    v_cvt_pk_bf16_f32 v29, 0, v216
    v_dot2c_f32_bf16 v16, v128, v28
    v_dot2c_f32_bf16 v17, v128, v29
    v_dot2c_f32_bf16 v18, v129, v28
    v_dot2c_f32_bf16 v19, v129, v29
    v_dot2c_f32_bf16 v20, v130, v28
    v_dot2c_f32_bf16 v21, v130, v29
    v_dot2c_f32_bf16 v22, v131, v28
    v_dot2c_f32_bf16 v23, v131, v29
    s_waitcnt vmcnt(6)
    v_add_f32 v27, v27, v217
    v_cvt_pk_bf16_f32 v30, v217, 0
    v_cvt_pk_bf16_f32 v31, 0, v217
    v_dot2c_f32_bf16 v16, v132, v30
    v_dot2c_f32_bf16 v17, v132, v31
    v_dot2c_f32_bf16 v18, v133, v30
    v_dot2c_f32_bf16 v19, v133, v31
    v_dot2c_f32_bf16 v20, v134, v30
    v_dot2c_f32_bf16 v21, v134, v31
    v_dot2c_f32_bf16 v22, v135, v30
    v_dot2c_f32_bf16 v23, v135, v31
    s_waitcnt vmcnt(5)
    v_add_f32 v27, v27, v218
    v_cvt_pk_bf16_f32 v28, v218, 0
    v_cvt_pk_bf16_f32 v29, 0, v218
    v_dot2c_f32_bf16 v16, v136, v28
    v_dot2c_f32_bf16 v17, v136, v29
    v_dot2c_f32_bf16 v18, v137, v28
    v_dot2c_f32_bf16 v19, v137, v29
    v_dot2c_f32_bf16 v20, v138, v28
    v_dot2c_f32_bf16 v21, v138, v29
    v_dot2c_f32_bf16 v22, v139, v28
    v_dot2c_f32_bf16 v23, v139, v29
    s_waitcnt vmcnt(4)
    v_add_f32 v27, v27, v219
    v_cvt_pk_bf16_f32 v30, v219, 0
    v_cvt_pk_bf16_f32 v31, 0, v219
    v_dot2c_f32_bf16 v16, v140, v30
    v_dot2c_f32_bf16 v17, v140, v31
    v_dot2c_f32_bf16 v18, v141, v30
    v_dot2c_f32_bf16 v19, v141, v31
    v_dot2c_f32_bf16 v20, v142, v30
    v_dot2c_f32_bf16 v21, v142, v31
    v_dot2c_f32_bf16 v22, v143, v30
    v_dot2c_f32_bf16 v23, v143, v31
    s_waitcnt vmcnt(3)
    v_add_f32 v27, v27, v220
    v_cvt_pk_bf16_f32 v28, v220, 0
    v_cvt_pk_bf16_f32 v29, 0, v220
    v_dot2c_f32_bf16 v16, v144, v28
    v_dot2c_f32_bf16 v17, v144, v29
    v_dot2c_f32_bf16 v18, v145, v28
    v_dot2c_f32_bf16 v19, v145, v29
    v_dot2c_f32_bf16 v20, v146, v28
    v_dot2c_f32_bf16 v21, v146, v29
    v_dot2c_f32_bf16 v22, v147, v28
    v_dot2c_f32_bf16 v23, v147, v29
    s_waitcnt vmcnt(2)
    v_add_f32 v27, v27, v221
    v_cvt_pk_bf16_f32 v30, v221, 0
    v_cvt_pk_bf16_f32 v31, 0, v221
    v_dot2c_f32_bf16 v16, v148, v30
    v_dot2c_f32_bf16 v17, v148, v31
    v_dot2c_f32_bf16 v18, v149, v30
    v_dot2c_f32_bf16 v19, v149, v31
    v_dot2c_f32_bf16 v20, v150, v30
    v_dot2c_f32_bf16 v21, v150, v31
    v_dot2c_f32_bf16 v22, v151, v30
    v_dot2c_f32_bf16 v23, v151, v31
    s_waitcnt vmcnt(1)
    v_add_f32 v27, v27, v222
    v_cvt_pk_bf16_f32 v28, v222, 0
    v_cvt_pk_bf16_f32 v29, 0, v222
    v_dot2c_f32_bf16 v16, v152, v28
    v_dot2c_f32_bf16 v17, v152, v29
    v_dot2c_f32_bf16 v18, v153, v28
    v_dot2c_f32_bf16 v19, v153, v29
    v_dot2c_f32_bf16 v20, v154, v28
    v_dot2c_f32_bf16 v21, v154, v29
    v_dot2c_f32_bf16 v22, v155, v28
    v_dot2c_f32_bf16 v23, v155, v29
    s_waitcnt vmcnt(0)
    v_add_f32 v27, v27, v223
    v_cvt_pk_bf16_f32 v30, v223, 0
    v_cvt_pk_bf16_f32 v31, 0, v223
    v_dot2c_f32_bf16 v16, v156, v30
    v_dot2c_f32_bf16 v17, v156, v31
    v_dot2c_f32_bf16 v18, v157, v30
    v_dot2c_f32_bf16 v19, v157, v31
    v_dot2c_f32_bf16 v20, v158, v30
    v_dot2c_f32_bf16 v21, v158, v31
    v_dot2c_f32_bf16 v22, v159, v30
    v_dot2c_f32_bf16 v23, v159, v31
    s_lshl_b32 s6, s5, 11
    v_lshlrev_b32 v10, 9, v4
    v_lshl_add_u32 v10, v3, 5, v10
    v_add_u32 v10, s6, v10
    s_nop 0
    ds_write_b128 v10, v[16:19]
    ds_write_b128 v10, v[20:23] offset:16
    s_lshl_b32 s6, s5, 5
    v_lshlrev_b32 v10, 3, v4
    v_add_u32 v10, s6, v10
    v_mov_b32 v25, v27
    ds_write_b64 v10, v[24:25] offset:8704
    s_waitcnt lgkmcnt(0)
    s_barrier
    v_cmp_gt_u32 vcc, 128, v0
    s_and_saveexec_b64 s[68:69], vcc
    s_cbranch_execz K1B_C1
    v_mov_b32 v10, 0
    ds_read_b128 v[48:51], v10 offset:8704
    ds_read_b128 v[52:55], v10 offset:8720
    ds_read_b128 v[56:59], v10 offset:8736
    ds_read_b128 v[60:63], v10 offset:8752
    ds_read_b128 v[64:67], v10 offset:8768
    ds_read_b128 v[68:71], v10 offset:8784
    ds_read_b128 v[72:75], v10 offset:8800
    ds_read_b128 v[76:79], v10 offset:8816
    v_lshlrev_b32 v10, 2, v0
    ds_read_b32 v16, v10 offset:0
    ds_read_b32 v17, v10 offset:512
    ds_read_b32 v18, v10 offset:1024
    ds_read_b32 v19, v10 offset:1536
    ds_read_b32 v20, v10 offset:2048
    ds_read_b32 v21, v10 offset:2560
    ds_read_b32 v22, v10 offset:3072
    ds_read_b32 v23, v10 offset:3584
    ds_read_b32 v24, v10 offset:4096
    ds_read_b32 v25, v10 offset:4608
    ds_read_b32 v26, v10 offset:5120
    ds_read_b32 v27, v10 offset:5632
    ds_read_b32 v28, v10 offset:6144
    ds_read_b32 v29, v10 offset:6656
    ds_read_b32 v30, v10 offset:7168
    ds_read_b32 v31, v10 offset:7680
    s_waitcnt lgkmcnt(0)
    v_max_f32 v40, v48, v56
    v_max3_f32 v40, v40, v64, v72
    v_sub_f32 v44, v48, v40
    v_mul_f32 v44, s47, v44
    v_exp_f32 v44, v44
    v_sub_f32 v45, v56, v40
    v_mul_f32 v45, s47, v45
    v_exp_f32 v45, v45
    v_sub_f32 v46, v64, v40
    v_mul_f32 v46, s47, v46
    v_exp_f32 v46, v46
    v_sub_f32 v47, v72, v40
    v_mul_f32 v47, s47, v47
    v_exp_f32 v47, v47
    v_mov_b32 v41, 0
    v_mov_b32 v42, 0
    v_add_f32 v16, v16, v17
    v_add_f32 v18, v18, v19
    v_add_f32 v16, v16, v18
    v_fmac_f32 v42, v16, v44
    v_add_f32 v49, v49, v51
    v_add_f32 v53, v53, v55
    v_add_f32 v49, v49, v53
    v_fmac_f32 v41, v49, v44
    v_add_f32 v20, v20, v21
    v_add_f32 v22, v22, v23
    v_add_f32 v20, v20, v22
    v_fmac_f32 v42, v20, v45
    v_add_f32 v57, v57, v59
    v_add_f32 v61, v61, v63
    v_add_f32 v57, v57, v61
    v_fmac_f32 v41, v57, v45
    v_add_f32 v24, v24, v25
    v_add_f32 v26, v26, v27
    v_add_f32 v24, v24, v26
    v_fmac_f32 v42, v24, v46
    v_add_f32 v65, v65, v67
    v_add_f32 v69, v69, v71
    v_add_f32 v65, v65, v69
    v_fmac_f32 v41, v65, v46
    v_add_f32 v28, v28, v29
    v_add_f32 v30, v30, v31
    v_add_f32 v28, v28, v30
    v_fmac_f32 v42, v28, v47
    v_add_f32 v73, v73, v75
    v_add_f32 v77, v77, v79
    v_add_f32 v73, v73, v77
    v_fmac_f32 v41, v73, v47
    s_lshl_b32 s6, s10, 1
    s_add_u32 s6, s6, s9
    s_lshl_b32 s6, s6, 10
    s_add_u32 s6, s6, 0x20000
    buffer_store_dword v42, v10, s[64:67], s6 offen sc1
    v_cmp_eq_u32 vcc, 0, v0
    s_and_b64 exec, exec, vcc
    buffer_store_dwordx2 v[40:41], v10, s[64:67], s6 offen offset:512 sc1
K1B_C1:
    s_mov_b64 exec, s[68:69]
    s_waitcnt vmcnt(0)
    s_barrier
    s_cmp_lg_u32 s5, 0
    s_cbranch_scc1 K1B_SG_S
    v_mov_b32 v11, 256
    s_mov_b64 exec, 1
    buffer_atomic_add v11, off, s[72:75], s70 offset:128 sc1
    s_mov_b64 exec, -1
K1B_SG_S:
    s_endpgm
K1_A:
    s_sub_u32 s8, s4, 4
    s_lshl_b32 s9, s7, 2
    s_add_u32 s9, s9, s8
    s_lshr_b32 s10, s9, 6
    s_lshr_b32 s14, s8, 1
    s_and_b32 s15, s8, 1
    s_mov_b32 s71, s8
    s_mov_b32 s48, s20
    s_mov_b32 s49, s21
    s_mov_b32 s50, 4194304
    s_mov_b32 s51, 0x00020000
    s_mov_b32 s52, s34
    s_mov_b32 s53, s35
    s_mov_b32 s54, 4194304
    s_mov_b32 s55, 0x00020000
    s_mov_b32 s56, s16
    s_mov_b32 s57, s17
    s_mov_b32 s58, 2048
    s_mov_b32 s59, 0x00020000
    s_mov_b32 s60, s28
    s_mov_b32 s61, s29
    s_mov_b32 s62, 2048
    s_mov_b32 s63, 0x00020000
    s_lshl_b32 s6, s71, 7
    s_lshl_b32 s12, s5, 5
    s_add_u32 s6, s6, s12
    v_lshlrev_b32 v5, 3, v4
    v_add_u32 v5, s6, v5
    v_lshlrev_b32 v6, 1, v5
    buffer_load_dwordx4 v[16:19], v6, s[56:59], 0 offen offset:0
    buffer_load_dwordx4 v[20:23], v6, s[56:59], 0 offen offset:1024
    buffer_load_dwordx4 v[24:27], v6, s[60:63], 0 offen offset:0
    buffer_load_dwordx4 v[28:31], v6, s[60:63], 0 offen offset:1024
    v_lshlrev_b32 v7, 13, v5
    s_lshl_b32 s6, s7, 8
    v_lshlrev_b32 v8, 4, v3
    v_add3_u32 v7, v7, s6, v8
    s_mov_b32 s6, 0
    buffer_load_dwordx4 v[96:99], v7, s[48:51], s6 offen nt
    s_add_u32 s6, s6, 8192
    buffer_load_dwordx4 v[100:103], v7, s[48:51], s6 offen nt
    s_add_u32 s6, s6, 8192
    buffer_load_dwordx4 v[104:107], v7, s[48:51], s6 offen nt
    s_add_u32 s6, s6, 8192
    buffer_load_dwordx4 v[108:111], v7, s[48:51], s6 offen nt
    s_add_u32 s6, s6, 8192
    buffer_load_dwordx4 v[112:115], v7, s[48:51], s6 offen nt
    s_add_u32 s6, s6, 8192
    buffer_load_dwordx4 v[116:119], v7, s[48:51], s6 offen nt
    s_add_u32 s6, s6, 8192
    buffer_load_dwordx4 v[120:123], v7, s[48:51], s6 offen nt
    s_add_u32 s6, s6, 8192
    buffer_load_dwordx4 v[124:127], v7, s[48:51], s6 offen nt
    s_add_u32 s6, s6, 8192
    s_mov_b32 s6, 0
    buffer_load_dwordx4 v[128:131], v7, s[52:55], s6 offen nt
    s_add_u32 s6, s6, 8192
    buffer_load_dwordx4 v[132:135], v7, s[52:55], s6 offen nt
    s_add_u32 s6, s6, 8192
    buffer_load_dwordx4 v[136:139], v7, s[52:55], s6 offen nt
    s_add_u32 s6, s6, 8192
    buffer_load_dwordx4 v[140:143], v7, s[52:55], s6 offen nt
    s_add_u32 s6, s6, 8192
    buffer_load_dwordx4 v[144:147], v7, s[52:55], s6 offen nt
    s_add_u32 s6, s6, 8192
    buffer_load_dwordx4 v[148:151], v7, s[52:55], s6 offen nt
    s_add_u32 s6, s6, 8192
    buffer_load_dwordx4 v[152:155], v7, s[52:55], s6 offen nt
    s_add_u32 s6, s6, 8192
    buffer_load_dwordx4 v[156:159], v7, s[52:55], s6 offen nt
    s_add_u32 s6, s6, 8192
    v_mov_b32 v48, 0
    v_mov_b32 v49, 0
    v_mov_b32 v50, 0
    v_mov_b32 v51, 0
    v_mov_b32 v52, 0
    v_mov_b32 v53, 0
    v_mov_b32 v54, 0
    v_mov_b32 v55, 0
    v_mov_b32 v56, 0
    v_mov_b32 v57, 0
    v_mov_b32 v58, 0
    v_mov_b32 v59, 0
    v_mov_b32 v60, 0
    v_mov_b32 v61, 0
    v_mov_b32 v62, 0
    v_mov_b32 v63, 0
    v_mov_b32 v64, 0
    v_mov_b32 v65, 0
    v_mov_b32 v66, 0
    v_mov_b32 v67, 0
    v_mov_b32 v68, 0
    v_mov_b32 v69, 0
    v_mov_b32 v70, 0
    v_mov_b32 v71, 0
    v_mov_b32 v72, 0
    v_mov_b32 v73, 0
    v_mov_b32 v74, 0
    v_mov_b32 v75, 0
    v_mov_b32 v76, 0
    v_mov_b32 v77, 0
    v_mov_b32 v78, 0
    v_mov_b32 v79, 0
    s_waitcnt vmcnt(15)
    v_and_b32 v80, 0xffff, v16
    v_lshlrev_b32 v81, 16, v16
    v_and_b32 v82, 0xffff, v20
    v_lshlrev_b32 v83, 16, v20
    v_dot2c_f32_bf16 v48, v96, v80
    v_dot2c_f32_bf16 v49, v96, v81
    v_dot2c_f32_bf16 v50, v97, v80
    v_dot2c_f32_bf16 v51, v97, v81
    v_dot2c_f32_bf16 v52, v98, v80
    v_dot2c_f32_bf16 v53, v98, v81
    v_dot2c_f32_bf16 v54, v99, v80
    v_dot2c_f32_bf16 v55, v99, v81
    v_dot2c_f32_bf16 v56, v96, v82
    v_dot2c_f32_bf16 v57, v96, v83
    v_dot2c_f32_bf16 v58, v97, v82
    v_dot2c_f32_bf16 v59, v97, v83
    v_dot2c_f32_bf16 v60, v98, v82
    v_dot2c_f32_bf16 v61, v98, v83
    v_dot2c_f32_bf16 v62, v99, v82
    v_dot2c_f32_bf16 v63, v99, v83
    s_waitcnt vmcnt(14)
    v_lshrrev_b32 v80, 16, v16
    v_and_b32 v81, s46, v16
    v_lshrrev_b32 v82, 16, v20
    v_and_b32 v83, s46, v20
    v_dot2c_f32_bf16 v48, v100, v80
    v_dot2c_f32_bf16 v49, v100, v81
    v_dot2c_f32_bf16 v50, v101, v80
    v_dot2c_f32_bf16 v51, v101, v81
    v_dot2c_f32_bf16 v52, v102, v80
    v_dot2c_f32_bf16 v53, v102, v81
    v_dot2c_f32_bf16 v54, v103, v80
    v_dot2c_f32_bf16 v55, v103, v81
    v_dot2c_f32_bf16 v56, v100, v82
    v_dot2c_f32_bf16 v57, v100, v83
    v_dot2c_f32_bf16 v58, v101, v82
    v_dot2c_f32_bf16 v59, v101, v83
    v_dot2c_f32_bf16 v60, v102, v82
    v_dot2c_f32_bf16 v61, v102, v83
    v_dot2c_f32_bf16 v62, v103, v82
    v_dot2c_f32_bf16 v63, v103, v83
    s_waitcnt vmcnt(13)
    v_and_b32 v80, 0xffff, v17
    v_lshlrev_b32 v81, 16, v17
    v_and_b32 v82, 0xffff, v21
    v_lshlrev_b32 v83, 16, v21
    v_dot2c_f32_bf16 v48, v104, v80
    v_dot2c_f32_bf16 v49, v104, v81
    v_dot2c_f32_bf16 v50, v105, v80
    v_dot2c_f32_bf16 v51, v105, v81
    v_dot2c_f32_bf16 v52, v106, v80
    v_dot2c_f32_bf16 v53, v106, v81
    v_dot2c_f32_bf16 v54, v107, v80
    v_dot2c_f32_bf16 v55, v107, v81
    v_dot2c_f32_bf16 v56, v104, v82
    v_dot2c_f32_bf16 v57, v104, v83
    v_dot2c_f32_bf16 v58, v105, v82
    v_dot2c_f32_bf16 v59, v105, v83
    v_dot2c_f32_bf16 v60, v106, v82
    v_dot2c_f32_bf16 v61, v106, v83
    v_dot2c_f32_bf16 v62, v107, v82
    v_dot2c_f32_bf16 v63, v107, v83
    s_waitcnt vmcnt(12)
    v_lshrrev_b32 v80, 16, v17
    v_and_b32 v81, s46, v17
    v_lshrrev_b32 v82, 16, v21
    v_and_b32 v83, s46, v21
    v_dot2c_f32_bf16 v48, v108, v80
    v_dot2c_f32_bf16 v49, v108, v81
    v_dot2c_f32_bf16 v50, v109, v80
    v_dot2c_f32_bf16 v51, v109, v81
    v_dot2c_f32_bf16 v52, v110, v80
    v_dot2c_f32_bf16 v53, v110, v81
    v_dot2c_f32_bf16 v54, v111, v80
    v_dot2c_f32_bf16 v55, v111, v81
    v_dot2c_f32_bf16 v56, v108, v82
    v_dot2c_f32_bf16 v57, v108, v83
    v_dot2c_f32_bf16 v58, v109, v82
    v_dot2c_f32_bf16 v59, v109, v83
    v_dot2c_f32_bf16 v60, v110, v82
    v_dot2c_f32_bf16 v61, v110, v83
    v_dot2c_f32_bf16 v62, v111, v82
    v_dot2c_f32_bf16 v63, v111, v83
    s_waitcnt vmcnt(11)
    v_and_b32 v80, 0xffff, v18
    v_lshlrev_b32 v81, 16, v18
    v_and_b32 v82, 0xffff, v22
    v_lshlrev_b32 v83, 16, v22
    v_dot2c_f32_bf16 v48, v112, v80
    v_dot2c_f32_bf16 v49, v112, v81
    v_dot2c_f32_bf16 v50, v113, v80
    v_dot2c_f32_bf16 v51, v113, v81
    v_dot2c_f32_bf16 v52, v114, v80
    v_dot2c_f32_bf16 v53, v114, v81
    v_dot2c_f32_bf16 v54, v115, v80
    v_dot2c_f32_bf16 v55, v115, v81
    v_dot2c_f32_bf16 v56, v112, v82
    v_dot2c_f32_bf16 v57, v112, v83
    v_dot2c_f32_bf16 v58, v113, v82
    v_dot2c_f32_bf16 v59, v113, v83
    v_dot2c_f32_bf16 v60, v114, v82
    v_dot2c_f32_bf16 v61, v114, v83
    v_dot2c_f32_bf16 v62, v115, v82
    v_dot2c_f32_bf16 v63, v115, v83
    s_waitcnt vmcnt(10)
    v_lshrrev_b32 v80, 16, v18
    v_and_b32 v81, s46, v18
    v_lshrrev_b32 v82, 16, v22
    v_and_b32 v83, s46, v22
    v_dot2c_f32_bf16 v48, v116, v80
    v_dot2c_f32_bf16 v49, v116, v81
    v_dot2c_f32_bf16 v50, v117, v80
    v_dot2c_f32_bf16 v51, v117, v81
    v_dot2c_f32_bf16 v52, v118, v80
    v_dot2c_f32_bf16 v53, v118, v81
    v_dot2c_f32_bf16 v54, v119, v80
    v_dot2c_f32_bf16 v55, v119, v81
    v_dot2c_f32_bf16 v56, v116, v82
    v_dot2c_f32_bf16 v57, v116, v83
    v_dot2c_f32_bf16 v58, v117, v82
    v_dot2c_f32_bf16 v59, v117, v83
    v_dot2c_f32_bf16 v60, v118, v82
    v_dot2c_f32_bf16 v61, v118, v83
    v_dot2c_f32_bf16 v62, v119, v82
    v_dot2c_f32_bf16 v63, v119, v83
    s_waitcnt vmcnt(9)
    v_and_b32 v80, 0xffff, v19
    v_lshlrev_b32 v81, 16, v19
    v_and_b32 v82, 0xffff, v23
    v_lshlrev_b32 v83, 16, v23
    v_dot2c_f32_bf16 v48, v120, v80
    v_dot2c_f32_bf16 v49, v120, v81
    v_dot2c_f32_bf16 v50, v121, v80
    v_dot2c_f32_bf16 v51, v121, v81
    v_dot2c_f32_bf16 v52, v122, v80
    v_dot2c_f32_bf16 v53, v122, v81
    v_dot2c_f32_bf16 v54, v123, v80
    v_dot2c_f32_bf16 v55, v123, v81
    v_dot2c_f32_bf16 v56, v120, v82
    v_dot2c_f32_bf16 v57, v120, v83
    v_dot2c_f32_bf16 v58, v121, v82
    v_dot2c_f32_bf16 v59, v121, v83
    v_dot2c_f32_bf16 v60, v122, v82
    v_dot2c_f32_bf16 v61, v122, v83
    v_dot2c_f32_bf16 v62, v123, v82
    v_dot2c_f32_bf16 v63, v123, v83
    s_waitcnt vmcnt(8)
    v_lshrrev_b32 v80, 16, v19
    v_and_b32 v81, s46, v19
    v_lshrrev_b32 v82, 16, v23
    v_and_b32 v83, s46, v23
    v_dot2c_f32_bf16 v48, v124, v80
    v_dot2c_f32_bf16 v49, v124, v81
    v_dot2c_f32_bf16 v50, v125, v80
    v_dot2c_f32_bf16 v51, v125, v81
    v_dot2c_f32_bf16 v52, v126, v80
    v_dot2c_f32_bf16 v53, v126, v81
    v_dot2c_f32_bf16 v54, v127, v80
    v_dot2c_f32_bf16 v55, v127, v81
    v_dot2c_f32_bf16 v56, v124, v82
    v_dot2c_f32_bf16 v57, v124, v83
    v_dot2c_f32_bf16 v58, v125, v82
    v_dot2c_f32_bf16 v59, v125, v83
    v_dot2c_f32_bf16 v60, v126, v82
    v_dot2c_f32_bf16 v61, v126, v83
    v_dot2c_f32_bf16 v62, v127, v82
    v_dot2c_f32_bf16 v63, v127, v83
    s_waitcnt vmcnt(7)
    v_and_b32 v80, 0xffff, v24
    v_lshlrev_b32 v81, 16, v24
    v_and_b32 v82, 0xffff, v28
    v_lshlrev_b32 v83, 16, v28
    v_dot2c_f32_bf16 v64, v128, v80
    v_dot2c_f32_bf16 v65, v128, v81
    v_dot2c_f32_bf16 v66, v129, v80
    v_dot2c_f32_bf16 v67, v129, v81
    v_dot2c_f32_bf16 v68, v130, v80
    v_dot2c_f32_bf16 v69, v130, v81
    v_dot2c_f32_bf16 v70, v131, v80
    v_dot2c_f32_bf16 v71, v131, v81
    v_dot2c_f32_bf16 v72, v128, v82
    v_dot2c_f32_bf16 v73, v128, v83
    v_dot2c_f32_bf16 v74, v129, v82
    v_dot2c_f32_bf16 v75, v129, v83
    v_dot2c_f32_bf16 v76, v130, v82
    v_dot2c_f32_bf16 v77, v130, v83
    v_dot2c_f32_bf16 v78, v131, v82
    v_dot2c_f32_bf16 v79, v131, v83
    s_waitcnt vmcnt(6)
    v_lshrrev_b32 v80, 16, v24
    v_and_b32 v81, s46, v24
    v_lshrrev_b32 v82, 16, v28
    v_and_b32 v83, s46, v28
    v_dot2c_f32_bf16 v64, v132, v80
    v_dot2c_f32_bf16 v65, v132, v81
    v_dot2c_f32_bf16 v66, v133, v80
    v_dot2c_f32_bf16 v67, v133, v81
    v_dot2c_f32_bf16 v68, v134, v80
    v_dot2c_f32_bf16 v69, v134, v81
    v_dot2c_f32_bf16 v70, v135, v80
    v_dot2c_f32_bf16 v71, v135, v81
    v_dot2c_f32_bf16 v72, v132, v82
    v_dot2c_f32_bf16 v73, v132, v83
    v_dot2c_f32_bf16 v74, v133, v82
    v_dot2c_f32_bf16 v75, v133, v83
    v_dot2c_f32_bf16 v76, v134, v82
    v_dot2c_f32_bf16 v77, v134, v83
    v_dot2c_f32_bf16 v78, v135, v82
    v_dot2c_f32_bf16 v79, v135, v83
    s_waitcnt vmcnt(5)
    v_and_b32 v80, 0xffff, v25
    v_lshlrev_b32 v81, 16, v25
    v_and_b32 v82, 0xffff, v29
    v_lshlrev_b32 v83, 16, v29
    v_dot2c_f32_bf16 v64, v136, v80
    v_dot2c_f32_bf16 v65, v136, v81
    v_dot2c_f32_bf16 v66, v137, v80
    v_dot2c_f32_bf16 v67, v137, v81
    v_dot2c_f32_bf16 v68, v138, v80
    v_dot2c_f32_bf16 v69, v138, v81
    v_dot2c_f32_bf16 v70, v139, v80
    v_dot2c_f32_bf16 v71, v139, v81
    v_dot2c_f32_bf16 v72, v136, v82
    v_dot2c_f32_bf16 v73, v136, v83
    v_dot2c_f32_bf16 v74, v137, v82
    v_dot2c_f32_bf16 v75, v137, v83
    v_dot2c_f32_bf16 v76, v138, v82
    v_dot2c_f32_bf16 v77, v138, v83
    v_dot2c_f32_bf16 v78, v139, v82
    v_dot2c_f32_bf16 v79, v139, v83
    s_waitcnt vmcnt(4)
    v_lshrrev_b32 v80, 16, v25
    v_and_b32 v81, s46, v25
    v_lshrrev_b32 v82, 16, v29
    v_and_b32 v83, s46, v29
    v_dot2c_f32_bf16 v64, v140, v80
    v_dot2c_f32_bf16 v65, v140, v81
    v_dot2c_f32_bf16 v66, v141, v80
    v_dot2c_f32_bf16 v67, v141, v81
    v_dot2c_f32_bf16 v68, v142, v80
    v_dot2c_f32_bf16 v69, v142, v81
    v_dot2c_f32_bf16 v70, v143, v80
    v_dot2c_f32_bf16 v71, v143, v81
    v_dot2c_f32_bf16 v72, v140, v82
    v_dot2c_f32_bf16 v73, v140, v83
    v_dot2c_f32_bf16 v74, v141, v82
    v_dot2c_f32_bf16 v75, v141, v83
    v_dot2c_f32_bf16 v76, v142, v82
    v_dot2c_f32_bf16 v77, v142, v83
    v_dot2c_f32_bf16 v78, v143, v82
    v_dot2c_f32_bf16 v79, v143, v83
    s_waitcnt vmcnt(3)
    v_and_b32 v80, 0xffff, v26
    v_lshlrev_b32 v81, 16, v26
    v_and_b32 v82, 0xffff, v30
    v_lshlrev_b32 v83, 16, v30
    v_dot2c_f32_bf16 v64, v144, v80
    v_dot2c_f32_bf16 v65, v144, v81
    v_dot2c_f32_bf16 v66, v145, v80
    v_dot2c_f32_bf16 v67, v145, v81
    v_dot2c_f32_bf16 v68, v146, v80
    v_dot2c_f32_bf16 v69, v146, v81
    v_dot2c_f32_bf16 v70, v147, v80
    v_dot2c_f32_bf16 v71, v147, v81
    v_dot2c_f32_bf16 v72, v144, v82
    v_dot2c_f32_bf16 v73, v144, v83
    v_dot2c_f32_bf16 v74, v145, v82
    v_dot2c_f32_bf16 v75, v145, v83
    v_dot2c_f32_bf16 v76, v146, v82
    v_dot2c_f32_bf16 v77, v146, v83
    v_dot2c_f32_bf16 v78, v147, v82
    v_dot2c_f32_bf16 v79, v147, v83
    s_waitcnt vmcnt(2)
    v_lshrrev_b32 v80, 16, v26
    v_and_b32 v81, s46, v26
    v_lshrrev_b32 v82, 16, v30
    v_and_b32 v83, s46, v30
    v_dot2c_f32_bf16 v64, v148, v80
    v_dot2c_f32_bf16 v65, v148, v81
    v_dot2c_f32_bf16 v66, v149, v80
    v_dot2c_f32_bf16 v67, v149, v81
    v_dot2c_f32_bf16 v68, v150, v80
    v_dot2c_f32_bf16 v69, v150, v81
    v_dot2c_f32_bf16 v70, v151, v80
    v_dot2c_f32_bf16 v71, v151, v81
    v_dot2c_f32_bf16 v72, v148, v82
    v_dot2c_f32_bf16 v73, v148, v83
    v_dot2c_f32_bf16 v74, v149, v82
    v_dot2c_f32_bf16 v75, v149, v83
    v_dot2c_f32_bf16 v76, v150, v82
    v_dot2c_f32_bf16 v77, v150, v83
    v_dot2c_f32_bf16 v78, v151, v82
    v_dot2c_f32_bf16 v79, v151, v83
    s_waitcnt vmcnt(1)
    v_and_b32 v80, 0xffff, v27
    v_lshlrev_b32 v81, 16, v27
    v_and_b32 v82, 0xffff, v31
    v_lshlrev_b32 v83, 16, v31
    v_dot2c_f32_bf16 v64, v152, v80
    v_dot2c_f32_bf16 v65, v152, v81
    v_dot2c_f32_bf16 v66, v153, v80
    v_dot2c_f32_bf16 v67, v153, v81
    v_dot2c_f32_bf16 v68, v154, v80
    v_dot2c_f32_bf16 v69, v154, v81
    v_dot2c_f32_bf16 v70, v155, v80
    v_dot2c_f32_bf16 v71, v155, v81
    v_dot2c_f32_bf16 v72, v152, v82
    v_dot2c_f32_bf16 v73, v152, v83
    v_dot2c_f32_bf16 v74, v153, v82
    v_dot2c_f32_bf16 v75, v153, v83
    v_dot2c_f32_bf16 v76, v154, v82
    v_dot2c_f32_bf16 v77, v154, v83
    v_dot2c_f32_bf16 v78, v155, v82
    v_dot2c_f32_bf16 v79, v155, v83
    s_waitcnt vmcnt(0)
    v_lshrrev_b32 v80, 16, v27
    v_and_b32 v81, s46, v27
    v_lshrrev_b32 v82, 16, v31
    v_and_b32 v83, s46, v31
    v_dot2c_f32_bf16 v64, v156, v80
    v_dot2c_f32_bf16 v65, v156, v81
    v_dot2c_f32_bf16 v66, v157, v80
    v_dot2c_f32_bf16 v67, v157, v81
    v_dot2c_f32_bf16 v68, v158, v80
    v_dot2c_f32_bf16 v69, v158, v81
    v_dot2c_f32_bf16 v70, v159, v80
    v_dot2c_f32_bf16 v71, v159, v81
    v_dot2c_f32_bf16 v72, v156, v82
    v_dot2c_f32_bf16 v73, v156, v83
    v_dot2c_f32_bf16 v74, v157, v82
    v_dot2c_f32_bf16 v75, v157, v83
    v_dot2c_f32_bf16 v76, v158, v82
    v_dot2c_f32_bf16 v77, v158, v83
    v_dot2c_f32_bf16 v78, v159, v82
    v_dot2c_f32_bf16 v79, v159, v83
    s_lshl_b32 s6, s5, 13
    v_lshlrev_b32 v10, 11, v4
    v_lshl_add_u32 v10, v3, 5, v10
    v_add_u32 v10, s6, v10
    ds_write_b128 v10, v[48:51] offset:0
    ds_write_b128 v10, v[52:55] offset:16
    ds_write_b128 v10, v[56:59] offset:512
    ds_write_b128 v10, v[60:63] offset:528
    ds_write_b128 v10, v[64:67] offset:1024
    ds_write_b128 v10, v[68:71] offset:1040
    ds_write_b128 v10, v[72:75] offset:1536
    ds_write_b128 v10, v[76:79] offset:1552
    s_waitcnt lgkmcnt(0)
    s_barrier
    v_lshlrev_b32 v10, 3, v0
    ds_read_b64 v[96:97], v10 offset:0
    ds_read_b64 v[98:99], v10 offset:2048
    ds_read_b64 v[100:101], v10 offset:4096
    ds_read_b64 v[102:103], v10 offset:6144
    ds_read_b64 v[104:105], v10 offset:8192
    ds_read_b64 v[106:107], v10 offset:10240
    ds_read_b64 v[108:109], v10 offset:12288
    ds_read_b64 v[110:111], v10 offset:14336
    ds_read_b64 v[112:113], v10 offset:16384
    ds_read_b64 v[114:115], v10 offset:18432
    ds_read_b64 v[116:117], v10 offset:20480
    ds_read_b64 v[118:119], v10 offset:22528
    ds_read_b64 v[120:121], v10 offset:24576
    ds_read_b64 v[122:123], v10 offset:26624
    ds_read_b64 v[124:125], v10 offset:28672
    ds_read_b64 v[126:127], v10 offset:30720
    s_waitcnt lgkmcnt(0)
    v_add_f32 v96, v96, v98
    v_add_f32 v97, v97, v99
    v_add_f32 v96, v96, v100
    v_add_f32 v97, v97, v101
    v_add_f32 v96, v96, v102
    v_add_f32 v97, v97, v103
    v_add_f32 v96, v96, v104
    v_add_f32 v97, v97, v105
    v_add_f32 v96, v96, v106
    v_add_f32 v97, v97, v107
    v_add_f32 v96, v96, v108
    v_add_f32 v97, v97, v109
    v_add_f32 v96, v96, v110
    v_add_f32 v97, v97, v111
    v_add_f32 v96, v96, v112
    v_add_f32 v97, v97, v113
    v_add_f32 v96, v96, v114
    v_add_f32 v97, v97, v115
    v_add_f32 v96, v96, v116
    v_add_f32 v97, v97, v117
    v_add_f32 v96, v96, v118
    v_add_f32 v97, v97, v119
    v_add_f32 v96, v96, v120
    v_add_f32 v97, v97, v121
    v_add_f32 v96, v96, v122
    v_add_f32 v97, v97, v123
    v_add_f32 v96, v96, v124
    v_add_f32 v97, v97, v125
    v_add_f32 v96, v96, v126
    v_add_f32 v97, v97, v127
    s_lshl_b32 s12, s7, 13
    s_lshl_b32 s13, s71, 11
    s_add_u32 s12, s12, s13
    s_add_u32 s12, s12, 0x600000
    buffer_store_dwordx2 v[96:97], v10, s[64:67], s12 offen sc1
    s_waitcnt vmcnt(0)
    s_barrier
    s_cmp_lg_u32 s5, 0
    s_cbranch_scc1 K1A_S0_S
    v_mov_b32 v11, 1
    s_mov_b64 exec, 1
    buffer_atomic_add v11, off, s[72:75], s70 offset:128 sc1
    s_mov_b64 exec, -1
K1A_S0_S:
    s_lshl_b32 s12, s9, 17
    s_add_u32 s56, s18, s12
    s_addc_u32 s57, s19, 0
    s_mov_b32 s58, 131072
    s_mov_b32 s59, 0x00020000
    s_mov_b32 s76, s24
    s_mov_b32 s77, s25
    s_mov_b32 s78, 4194304
    s_mov_b32 s79, 0x00020000
    s_mov_b32 s80, s26
    s_mov_b32 s81, s27
    s_mov_b32 s82, 4194304
    s_mov_b32 s83, 0x00020000
    s_mov_b32 s48, s36
    s_mov_b32 s49, s37
    s_mov_b32 s50, 4194304
    s_mov_b32 s51, 0x00020000
    v_lshlrev_b32 v12, 4, v2
    v_and_b32 v5, 31, v2
    v_lshrrev_b32 v6, 5, v2
    s_lshl_b32 s12, s5, 15
    v_xor_b32 v10, 0, v12
    s_add_u32 s13, s12, 0
    s_mov_b32 m0, s13
    s_nop 0
    buffer_load_dwordx4 v10, s[56:59], s13 offen nt lds
    v_xor_b32 v10, 64, v12
    s_add_u32 s13, s12, 1024
    s_mov_b32 m0, s13
    s_nop 0
    buffer_load_dwordx4 v10, s[56:59], s13 offen nt lds
    v_xor_b32 v10, 128, v12
    s_add_u32 s13, s12, 2048
    s_mov_b32 m0, s13
    s_nop 0
    buffer_load_dwordx4 v10, s[56:59], s13 offen nt lds
    v_xor_b32 v10, 192, v12
    s_add_u32 s13, s12, 3072
    s_mov_b32 m0, s13
    s_nop 0
    buffer_load_dwordx4 v10, s[56:59], s13 offen nt lds
    v_xor_b32 v10, 16, v12
    s_add_u32 s13, s12, 4096
    s_mov_b32 m0, s13
    s_nop 0
    buffer_load_dwordx4 v10, s[56:59], s13 offen nt lds
    v_xor_b32 v10, 80, v12
    s_add_u32 s13, s12, 5120
    s_mov_b32 m0, s13
    s_nop 0
    buffer_load_dwordx4 v10, s[56:59], s13 offen nt lds
    v_xor_b32 v10, 144, v12
    s_add_u32 s13, s12, 6144
    s_mov_b32 m0, s13
    s_nop 0
    buffer_load_dwordx4 v10, s[56:59], s13 offen nt lds
    v_xor_b32 v10, 208, v12
    s_add_u32 s13, s12, 7168
    s_mov_b32 m0, s13
    s_nop 0
    buffer_load_dwordx4 v10, s[56:59], s13 offen nt lds
    v_xor_b32 v10, 32, v12
    s_add_u32 s13, s12, 8192
    s_mov_b32 m0, s13
    s_nop 0
    buffer_load_dwordx4 v10, s[56:59], s13 offen nt lds
    v_xor_b32 v10, 96, v12
    s_add_u32 s13, s12, 9216
    s_mov_b32 m0, s13
    s_nop 0
    buffer_load_dwordx4 v10, s[56:59], s13 offen nt lds
    v_xor_b32 v10, 160, v12
    s_add_u32 s13, s12, 10240
    s_mov_b32 m0, s13
    s_nop 0
    buffer_load_dwordx4 v10, s[56:59], s13 offen nt lds
    v_xor_b32 v10, 224, v12
    s_add_u32 s13, s12, 11264
    s_mov_b32 m0, s13
    s_nop 0
    buffer_load_dwordx4 v10, s[56:59], s13 offen nt lds
    v_xor_b32 v10, 48, v12
    s_add_u32 s13, s12, 12288
    s_mov_b32 m0, s13
    s_nop 0
    buffer_load_dwordx4 v10, s[56:59], s13 offen nt lds
    v_xor_b32 v10, 112, v12
    s_add_u32 s13, s12, 13312
    s_mov_b32 m0, s13
    s_nop 0
    buffer_load_dwordx4 v10, s[56:59], s13 offen nt lds
    v_xor_b32 v10, 176, v12
    s_add_u32 s13, s12, 14336
    s_mov_b32 m0, s13
    s_nop 0
    buffer_load_dwordx4 v10, s[56:59], s13 offen nt lds
    v_xor_b32 v10, 240, v12
    s_add_u32 s13, s12, 15360
    s_mov_b32 m0, s13
    s_nop 0
    buffer_load_dwordx4 v10, s[56:59], s13 offen nt lds
    v_xor_b32 v10, 0, v12
    s_add_u32 s13, s12, 16384
    s_mov_b32 m0, s13
    s_nop 0
    buffer_load_dwordx4 v10, s[56:59], s13 offen nt lds
    v_xor_b32 v10, 64, v12
    s_add_u32 s13, s12, 17408
    s_mov_b32 m0, s13
    s_nop 0
    buffer_load_dwordx4 v10, s[56:59], s13 offen nt lds
    v_xor_b32 v10, 128, v12
    s_add_u32 s13, s12, 18432
    s_mov_b32 m0, s13
    s_nop 0
    buffer_load_dwordx4 v10, s[56:59], s13 offen nt lds
    v_xor_b32 v10, 192, v12
    s_add_u32 s13, s12, 19456
    s_mov_b32 m0, s13
    s_nop 0
    buffer_load_dwordx4 v10, s[56:59], s13 offen nt lds
    v_xor_b32 v10, 16, v12
    s_add_u32 s13, s12, 20480
    s_mov_b32 m0, s13
    s_nop 0
    buffer_load_dwordx4 v10, s[56:59], s13 offen nt lds
    v_xor_b32 v10, 80, v12
    s_add_u32 s13, s12, 21504
    s_mov_b32 m0, s13
    s_nop 0
    buffer_load_dwordx4 v10, s[56:59], s13 offen nt lds
    v_xor_b32 v10, 144, v12
    s_add_u32 s13, s12, 22528
    s_mov_b32 m0, s13
    s_nop 0
    buffer_load_dwordx4 v10, s[56:59], s13 offen nt lds
    v_xor_b32 v10, 208, v12
    s_add_u32 s13, s12, 23552
    s_mov_b32 m0, s13
    s_nop 0
    buffer_load_dwordx4 v10, s[56:59], s13 offen nt lds
    v_xor_b32 v10, 32, v12
    s_add_u32 s13, s12, 24576
    s_mov_b32 m0, s13
    s_nop 0
    buffer_load_dwordx4 v10, s[56:59], s13 offen nt lds
    v_xor_b32 v10, 96, v12
    s_add_u32 s13, s12, 25600
    s_mov_b32 m0, s13
    s_nop 0
    buffer_load_dwordx4 v10, s[56:59], s13 offen nt lds
    v_xor_b32 v10, 160, v12
    s_add_u32 s13, s12, 26624
    s_mov_b32 m0, s13
    s_nop 0
    buffer_load_dwordx4 v10, s[56:59], s13 offen nt lds
    v_xor_b32 v10, 224, v12
    s_add_u32 s13, s12, 27648
    s_mov_b32 m0, s13
    s_nop 0
    buffer_load_dwordx4 v10, s[56:59], s13 offen nt lds
    v_xor_b32 v10, 48, v12
    s_add_u32 s13, s12, 28672
    s_mov_b32 m0, s13
    s_nop 0
    buffer_load_dwordx4 v10, s[56:59], s13 offen nt lds
    v_xor_b32 v10, 112, v12
    s_add_u32 s13, s12, 29696
    s_mov_b32 m0, s13
    s_nop 0
    buffer_load_dwordx4 v10, s[56:59], s13 offen nt lds
    v_xor_b32 v10, 176, v12
    s_add_u32 s13, s12, 30720
    s_mov_b32 m0, s13
    s_nop 0
    buffer_load_dwordx4 v10, s[56:59], s13 offen nt lds
    v_xor_b32 v10, 240, v12
    s_add_u32 s13, s12, 31744
    s_mov_b32 m0, s13
    s_nop 0
    buffer_load_dwordx4 v10, s[56:59], s13 offen nt lds
    s_lshl_b32 s6, s5, 7
    v_lshrrev_b32 v13, 3, v2
    v_lshlrev_b32 v13, 4, v13
    v_add_u32 v13, s6, v13
    v_lshlrev_b32 v13, 13, v13
    s_lshl_b32 s6, s7, 8
    s_lshl_b32 s13, s15, 7
    s_add_u32 s6, s6, s13
    v_and_b32 v10, 7, v2
    v_lshlrev_b32 v10, 4, v10
    v_add3_u32 v1, v13, s6, v10
    s_mov_b32 s85, 0
    s_lshl_b32 s84, s7, 17
    s_lshl_b32 s13, s15, 16
    s_add_u32 s84, s84, s13
    s_lshl_b32 s13, s5, 14
    s_add_u32 s84, s84, s13
    s_mov_b32 s86, s84
    s_waitcnt vmcnt(19)
    buffer_load_dwordx4 a[0:3], v1, s[76:79], s85 offen nt
    s_add_u32 s85, s85, 8192
    s_waitcnt vmcnt(19)
    buffer_load_dwordx4 a[4:7], v1, s[76:79], s85 offen nt
    s_add_u32 s85, s85, 8192
    s_waitcnt vmcnt(19)
    buffer_load_dwordx4 a[8:11], v1, s[76:79], s85 offen nt
    s_add_u32 s85, s85, 8192
    s_waitcnt vmcnt(19)
    buffer_load_dwordx4 a[12:15], v1, s[76:79], s85 offen nt
    s_add_u32 s85, s85, 8192
    s_waitcnt vmcnt(19)
    buffer_load_dwordx4 a[16:19], v1, s[76:79], s85 offen nt
    s_add_u32 s85, s85, 8192
    s_waitcnt vmcnt(19)
    buffer_load_dwordx4 a[20:23], v1, s[76:79], s85 offen nt
    s_add_u32 s85, s85, 8192
    s_waitcnt vmcnt(19)
    buffer_load_dwordx4 a[24:27], v1, s[76:79], s85 offen nt
    s_add_u32 s85, s85, 8192
    s_waitcnt vmcnt(19)
    buffer_load_dwordx4 a[28:31], v1, s[76:79], s85 offen nt
    s_add_u32 s85, s85, 8192
    s_waitcnt vmcnt(19)
    buffer_load_dwordx4 a[32:35], v1, s[76:79], s85 offen nt
    s_add_u32 s85, s85, 8192
    s_waitcnt vmcnt(19)
    buffer_load_dwordx4 a[36:39], v1, s[76:79], s85 offen nt
    s_add_u32 s85, s85, 8192
    s_waitcnt vmcnt(19)
    buffer_load_dwordx4 a[40:43], v1, s[76:79], s85 offen nt
    s_add_u32 s85, s85, 8192
    s_waitcnt vmcnt(19)
    buffer_load_dwordx4 a[44:47], v1, s[76:79], s85 offen nt
    s_add_u32 s85, s85, 8192
    s_waitcnt vmcnt(19)
    buffer_load_dwordx4 a[48:51], v1, s[76:79], s85 offen nt
    s_add_u32 s85, s85, 8192
    s_waitcnt vmcnt(19)
    buffer_load_dwordx4 a[52:55], v1, s[76:79], s85 offen nt
    s_add_u32 s85, s85, 8192
    s_waitcnt vmcnt(19)
    buffer_load_dwordx4 a[56:59], v1, s[76:79], s85 offen nt
    s_add_u32 s85, s85, 8192
    s_waitcnt vmcnt(19)
    buffer_load_dwordx4 a[60:63], v1, s[76:79], s85 offen nt
    s_add_u32 s85, s85, 8192
    s_waitcnt vmcnt(0)
    s_cmp_lg_u32 s5, 0
    s_cbranch_scc1 K1A_P1_OK
K1A_P1_L:
    buffer_load_dword v11, off, s[72:75], 0 offset:0 sc1
    s_waitcnt vmcnt(0)
    v_readfirstlane_b32 s13, v11
    s_cmp_ge_u32 s13, 128
    s_cbranch_scc1 K1A_P1_OK
    s_sleep 1
    s_branch K1A_P1_L
K1A_P1_OK:
    s_barrier
    s_lshl_b32 s12, s10, 15
    buffer_load_dwordx4 v[128:131], v12, s[64:67], s12 offen offset:0 sc1
    buffer_load_dwordx4 v[132:135], v12, s[64:67], s12 offen offset:1024 sc1
    buffer_load_dwordx4 v[136:139], v12, s[64:67], s12 offen offset:2048 sc1
    buffer_load_dwordx4 v[140:143], v12, s[64:67], s12 offen offset:3072 sc1
    s_add_u32 s12, s12, 4096
    buffer_load_dwordx4 v[144:147], v12, s[64:67], s12 offen offset:0 sc1
    buffer_load_dwordx4 v[148:151], v12, s[64:67], s12 offen offset:1024 sc1
    buffer_load_dwordx4 v[152:155], v12, s[64:67], s12 offen offset:2048 sc1
    buffer_load_dwordx4 v[156:159], v12, s[64:67], s12 offen offset:3072 sc1
    s_add_u32 s12, s12, 4096
    buffer_load_dwordx4 v[160:163], v12, s[64:67], s12 offen offset:0 sc1
    buffer_load_dwordx4 v[164:167], v12, s[64:67], s12 offen offset:1024 sc1
    buffer_load_dwordx4 v[168:171], v12, s[64:67], s12 offen offset:2048 sc1
    buffer_load_dwordx4 v[172:175], v12, s[64:67], s12 offen offset:3072 sc1
    s_add_u32 s12, s12, 4096
    buffer_load_dwordx4 v[176:179], v12, s[64:67], s12 offen offset:0 sc1
    buffer_load_dwordx4 v[180:183], v12, s[64:67], s12 offen offset:1024 sc1
    buffer_load_dwordx4 v[184:187], v12, s[64:67], s12 offen offset:2048 sc1
    buffer_load_dwordx4 v[188:191], v12, s[64:67], s12 offen offset:3072 sc1
    s_add_u32 s12, s12, 4096
    buffer_load_dwordx4 v[192:195], v12, s[64:67], s12 offen offset:0 sc1
    buffer_load_dwordx4 v[196:199], v12, s[64:67], s12 offen offset:1024 sc1
    buffer_load_dwordx4 v[200:203], v12, s[64:67], s12 offen offset:2048 sc1
    buffer_load_dwordx4 v[204:207], v12, s[64:67], s12 offen offset:3072 sc1
    s_add_u32 s12, s12, 4096
    buffer_load_dwordx4 v[208:211], v12, s[64:67], s12 offen offset:0 sc1
    buffer_load_dwordx4 v[212:215], v12, s[64:67], s12 offen offset:1024 sc1
    buffer_load_dwordx4 v[216:219], v12, s[64:67], s12 offen offset:2048 sc1
    buffer_load_dwordx4 v[220:223], v12, s[64:67], s12 offen offset:3072 sc1
    s_add_u32 s12, s12, 4096
    buffer_load_dwordx4 v[224:227], v12, s[64:67], s12 offen offset:0 sc1
    buffer_load_dwordx4 v[228:231], v12, s[64:67], s12 offen offset:1024 sc1
    buffer_load_dwordx4 v[232:235], v12, s[64:67], s12 offen offset:2048 sc1
    buffer_load_dwordx4 v[236:239], v12, s[64:67], s12 offen offset:3072 sc1
    s_add_u32 s12, s12, 4096
    buffer_load_dwordx4 v[240:243], v12, s[64:67], s12 offen offset:0 sc1
    buffer_load_dwordx4 v[244:247], v12, s[64:67], s12 offen offset:1024 sc1
    buffer_load_dwordx4 v[248:251], v12, s[64:67], s12 offen offset:2048 sc1
    buffer_load_dwordx4 v[252:255], v12, s[64:67], s12 offen offset:3072 sc1
    v_and_b32 v7, 3, v5
    v_lshlrev_b32 v7, 2, v7
    v_bfe_u32 v8, v5, 2, 2
    v_or_b32 v7, v7, v8
    s_lshl_b32 s12, s5, 15
    v_lshlrev_b32 v8, 10, v5
    v_add_u32 v8, s12, v8
    v_or_b32 v9, 0, v6
    v_xor_b32 v9, v9, v7
    v_lshl_add_u32 v16, v9, 4, v8
    v_or_b32 v9, 2, v6
    v_xor_b32 v9, v9, v7
    v_lshl_add_u32 v17, v9, 4, v8
    v_or_b32 v9, 4, v6
    v_xor_b32 v9, v9, v7
    v_lshl_add_u32 v18, v9, 4, v8
    v_or_b32 v9, 6, v6
    v_xor_b32 v9, v9, v7
    v_lshl_add_u32 v19, v9, 4, v8
    v_or_b32 v9, 8, v6
    v_xor_b32 v9, v9, v7
    v_lshl_add_u32 v20, v9, 4, v8
    v_or_b32 v9, 10, v6
    v_xor_b32 v9, v9, v7
    v_lshl_add_u32 v21, v9, 4, v8
    v_or_b32 v9, 12, v6
    v_xor_b32 v9, v9, v7
    v_lshl_add_u32 v22, v9, 4, v8
    v_or_b32 v9, 14, v6
    v_xor_b32 v9, v9, v7
    v_lshl_add_u32 v23, v9, 4, v8
    v_bfe_u32 v9, v2, 2, 2
    v_bfe_u32 v10, v2, 4, 1
    v_bfe_u32 v11, v2, 1, 1
    v_lshl_add_u32 v10, v10, 1, v11
    v_and_b32 v11, 1, v2
    v_lshlrev_b32 v11, 3, v11
    s_lshl_b32 s12, s5, 8
    v_add_u32 v11, s12, v11
    v_lshl_add_u32 v13, v6, 2, v9
    v_lshl_add_u32 v11, v13, 10, v11
    v_or_b32 v13, 0, v6
    v_lshl_add_u32 v13, v9, 2, v13
    v_or_b32 v14, 0, v10
    v_xor_b32 v14, v14, v13
    v_lshl_add_u32 v24, v14, 4, v11
    v_add_u32 v96, 0x10000, v24
    v_or_b32 v14, 4, v10
    v_xor_b32 v14, v14, v13
    v_lshl_add_u32 v25, v14, 4, v11
    v_add_u32 v97, 0x10000, v25
    v_or_b32 v14, 8, v10
    v_xor_b32 v14, v14, v13
    v_lshl_add_u32 v26, v14, 4, v11
    v_add_u32 v98, 0x10000, v26
    v_or_b32 v14, 12, v10
    v_xor_b32 v14, v14, v13
    v_lshl_add_u32 v27, v14, 4, v11
    v_add_u32 v99, 0x10000, v27
    v_or_b32 v13, 2, v6
    v_lshl_add_u32 v13, v9, 2, v13
    v_or_b32 v14, 0, v10
    v_xor_b32 v14, v14, v13
    v_lshl_add_u32 v28, v14, 4, v11
    v_add_u32 v100, 0x10000, v28
    v_or_b32 v14, 4, v10
    v_xor_b32 v14, v14, v13
    v_lshl_add_u32 v29, v14, 4, v11
    v_add_u32 v101, 0x10000, v29
    v_or_b32 v14, 8, v10
    v_xor_b32 v14, v14, v13
    v_lshl_add_u32 v30, v14, 4, v11
    v_add_u32 v102, 0x10000, v30
    v_or_b32 v14, 12, v10
    v_xor_b32 v14, v14, v13
    v_lshl_add_u32 v31, v14, 4, v11
    v_add_u32 v103, 0x10000, v31
    ds_read_b128 v[32:35], v16 offset:0
    ds_read_b128 v[36:39], v17 offset:0
    ds_read_b128 v[40:43], v18 offset:0
    ds_read_b128 v[44:47], v19 offset:0
    ds_read_b128 v[48:51], v20 offset:0
    ds_read_b128 v[52:55], v21 offset:0
    ds_read_b128 v[56:59], v22 offset:0
    ds_read_b128 v[60:63], v23 offset:0
    ds_read_b128 v[64:67], v16 offset:256
    s_waitcnt vmcnt(31) lgkmcnt(8)
    v_mfma_f32_32x32x16_bf16 v[104:119], v[32:35], v[128:131], 0
    ds_read_b128 v[68:71], v17 offset:256
    s_waitcnt vmcnt(30) lgkmcnt(8)
    v_mfma_f32_32x32x16_bf16 v[104:119], v[36:39], v[132:135], v[104:119]
    ds_read_b128 v[72:75], v18 offset:256
    s_waitcnt vmcnt(29) lgkmcnt(8)
    v_mfma_f32_32x32x16_bf16 v[104:119], v[40:43], v[136:139], v[104:119]
    ds_read_b128 v[76:79], v19 offset:256
    s_waitcnt vmcnt(28) lgkmcnt(8)
    v_mfma_f32_32x32x16_bf16 v[104:119], v[44:47], v[140:143], v[104:119]
    ds_read_b128 v[80:83], v20 offset:256
    s_waitcnt vmcnt(27) lgkmcnt(8)
    v_mfma_f32_32x32x16_bf16 v[104:119], v[48:51], v[144:147], v[104:119]
    ds_read_b128 v[84:87], v21 offset:256
    s_waitcnt vmcnt(26) lgkmcnt(8)
    v_mfma_f32_32x32x16_bf16 v[104:119], v[52:55], v[148:151], v[104:119]
    ds_read_b128 v[88:91], v22 offset:256
    s_waitcnt vmcnt(25) lgkmcnt(8)
    v_mfma_f32_32x32x16_bf16 v[104:119], v[56:59], v[152:155], v[104:119]
    ds_read_b128 v[92:95], v23 offset:256
    s_waitcnt vmcnt(24) lgkmcnt(8)
    v_mfma_f32_32x32x16_bf16 v[104:119], v[60:63], v[156:159], v[104:119]
    ds_read_b128 v[32:35], v16 offset:512
    s_waitcnt vmcnt(23) lgkmcnt(8)
    v_mfma_f32_32x32x16_bf16 v[104:119], v[64:67], v[160:163], v[104:119]
    ds_read_b128 v[36:39], v17 offset:512
    s_waitcnt vmcnt(22) lgkmcnt(8)
    v_mfma_f32_32x32x16_bf16 v[104:119], v[68:71], v[164:167], v[104:119]
    ds_read_b128 v[40:43], v18 offset:512
    s_waitcnt vmcnt(21) lgkmcnt(8)
    v_mfma_f32_32x32x16_bf16 v[104:119], v[72:75], v[168:171], v[104:119]
    ds_read_b128 v[44:47], v19 offset:512
    s_waitcnt vmcnt(20) lgkmcnt(8)
    v_mfma_f32_32x32x16_bf16 v[104:119], v[76:79], v[172:175], v[104:119]
    ds_read_b128 v[48:51], v20 offset:512
    s_waitcnt vmcnt(19) lgkmcnt(8)
    v_mfma_f32_32x32x16_bf16 v[104:119], v[80:83], v[176:179], v[104:119]
    ds_read_b128 v[52:55], v21 offset:512
    s_waitcnt vmcnt(18) lgkmcnt(8)
    v_mfma_f32_32x32x16_bf16 v[104:119], v[84:87], v[180:183], v[104:119]
    ds_read_b128 v[56:59], v22 offset:512
    s_waitcnt vmcnt(17) lgkmcnt(8)
    v_mfma_f32_32x32x16_bf16 v[104:119], v[88:91], v[184:187], v[104:119]
    ds_read_b128 v[60:63], v23 offset:512
    s_waitcnt vmcnt(16) lgkmcnt(8)
    v_mfma_f32_32x32x16_bf16 v[104:119], v[92:95], v[188:191], v[104:119]
    ds_read_b128 v[64:67], v16 offset:768
    s_waitcnt vmcnt(15) lgkmcnt(8)
    v_mfma_f32_32x32x16_bf16 v[104:119], v[32:35], v[192:195], v[104:119]
    ds_read_b128 v[68:71], v17 offset:768
    s_waitcnt vmcnt(14) lgkmcnt(8)
    v_mfma_f32_32x32x16_bf16 v[104:119], v[36:39], v[196:199], v[104:119]
    ds_read_b128 v[72:75], v18 offset:768
    s_waitcnt vmcnt(13) lgkmcnt(8)
    v_mfma_f32_32x32x16_bf16 v[104:119], v[40:43], v[200:203], v[104:119]
    ds_read_b128 v[76:79], v19 offset:768
    s_waitcnt vmcnt(12) lgkmcnt(8)
    v_mfma_f32_32x32x16_bf16 v[104:119], v[44:47], v[204:207], v[104:119]
    ds_read_b128 v[80:83], v20 offset:768
    s_waitcnt vmcnt(11) lgkmcnt(8)
    v_mfma_f32_32x32x16_bf16 v[104:119], v[48:51], v[208:211], v[104:119]
    ds_read_b128 v[84:87], v21 offset:768
    s_waitcnt vmcnt(10) lgkmcnt(8)
    v_mfma_f32_32x32x16_bf16 v[104:119], v[52:55], v[212:215], v[104:119]
    ds_read_b128 v[88:91], v22 offset:768
    s_waitcnt vmcnt(9) lgkmcnt(8)
    v_mfma_f32_32x32x16_bf16 v[104:119], v[56:59], v[216:219], v[104:119]
    ds_read_b128 v[92:95], v23 offset:768
    s_waitcnt vmcnt(8) lgkmcnt(8)
    v_mfma_f32_32x32x16_bf16 v[104:119], v[60:63], v[220:223], v[104:119]
    s_waitcnt vmcnt(7) lgkmcnt(7)
    v_mfma_f32_32x32x16_bf16 v[104:119], v[64:67], v[224:227], v[104:119]
    s_waitcnt vmcnt(6) lgkmcnt(6)
    v_mfma_f32_32x32x16_bf16 v[104:119], v[68:71], v[228:231], v[104:119]
    s_waitcnt vmcnt(5) lgkmcnt(5)
    v_mfma_f32_32x32x16_bf16 v[104:119], v[72:75], v[232:235], v[104:119]
    s_waitcnt vmcnt(4) lgkmcnt(4)
    v_mfma_f32_32x32x16_bf16 v[104:119], v[76:79], v[236:239], v[104:119]
    s_waitcnt vmcnt(3) lgkmcnt(3)
    v_mfma_f32_32x32x16_bf16 v[104:119], v[80:83], v[240:243], v[104:119]
    s_waitcnt vmcnt(2) lgkmcnt(2)
    v_mfma_f32_32x32x16_bf16 v[104:119], v[84:87], v[244:247], v[104:119]
    s_waitcnt vmcnt(1) lgkmcnt(1)
    v_mfma_f32_32x32x16_bf16 v[104:119], v[88:91], v[248:251], v[104:119]
    s_waitcnt vmcnt(0) lgkmcnt(0)
    v_mfma_f32_32x32x16_bf16 v[104:119], v[92:95], v[252:255], v[104:119]
    s_nop 7
    s_nop 3
    v_cvt_pk_bf16_f32 v32, v104, v105
    v_lshlrev_b32 v104, 16, v32
    v_and_b32 v105, s46, v32
    v_mul_f32 v104, s45, v104
    v_mul_f32 v105, s45, v105
    v_cvt_pk_bf16_f32 v32, v104, v105
    v_lshlrev_b32 v104, 16, v32
    v_and_b32 v105, s46, v32
    v_cvt_pk_bf16_f32 v32, v106, v107
    v_lshlrev_b32 v106, 16, v32
    v_and_b32 v107, s46, v32
    v_mul_f32 v106, s45, v106
    v_mul_f32 v107, s45, v107
    v_cvt_pk_bf16_f32 v32, v106, v107
    v_lshlrev_b32 v106, 16, v32
    v_and_b32 v107, s46, v32
    v_cvt_pk_bf16_f32 v32, v108, v109
    v_lshlrev_b32 v108, 16, v32
    v_and_b32 v109, s46, v32
    v_mul_f32 v108, s45, v108
    v_mul_f32 v109, s45, v109
    v_cvt_pk_bf16_f32 v32, v108, v109
    v_lshlrev_b32 v108, 16, v32
    v_and_b32 v109, s46, v32
    v_cvt_pk_bf16_f32 v32, v110, v111
    v_lshlrev_b32 v110, 16, v32
    v_and_b32 v111, s46, v32
    v_mul_f32 v110, s45, v110
    v_mul_f32 v111, s45, v111
    v_cvt_pk_bf16_f32 v32, v110, v111
    v_lshlrev_b32 v110, 16, v32
    v_and_b32 v111, s46, v32
    v_cvt_pk_bf16_f32 v32, v112, v113
    v_lshlrev_b32 v112, 16, v32
    v_and_b32 v113, s46, v32
    v_mul_f32 v112, s45, v112
    v_mul_f32 v113, s45, v113
    v_cvt_pk_bf16_f32 v32, v112, v113
    v_lshlrev_b32 v112, 16, v32
    v_and_b32 v113, s46, v32
    v_cvt_pk_bf16_f32 v32, v114, v115
    v_lshlrev_b32 v114, 16, v32
    v_and_b32 v115, s46, v32
    v_mul_f32 v114, s45, v114
    v_mul_f32 v115, s45, v115
    v_cvt_pk_bf16_f32 v32, v114, v115
    v_lshlrev_b32 v114, 16, v32
    v_and_b32 v115, s46, v32
    v_cvt_pk_bf16_f32 v32, v116, v117
    v_lshlrev_b32 v116, 16, v32
    v_and_b32 v117, s46, v32
    v_mul_f32 v116, s45, v116
    v_mul_f32 v117, s45, v117
    v_cvt_pk_bf16_f32 v32, v116, v117
    v_lshlrev_b32 v116, 16, v32
    v_and_b32 v117, s46, v32
    v_cvt_pk_bf16_f32 v32, v118, v119
    v_lshlrev_b32 v118, 16, v32
    v_and_b32 v119, s46, v32
    v_mul_f32 v118, s45, v118
    v_mul_f32 v119, s45, v119
    v_cvt_pk_bf16_f32 v32, v118, v119
    v_lshlrev_b32 v118, 16, v32
    v_and_b32 v119, s46, v32
    v_max3_f32 v32, v104, v105, v106
    v_max3_f32 v32, v32, v107, v108
    v_max3_f32 v32, v32, v109, v110
    v_max3_f32 v32, v32, v111, v112
    v_max3_f32 v32, v32, v113, v114
    v_max3_f32 v32, v32, v115, v116
    v_max3_f32 v32, v32, v117, v118
    v_max_f32 v32, v32, v119
    v_mov_b32 v33, v32
    s_nop 1
    v_permlane32_swap_b32 v32, v33
    s_nop 1
    v_max_f32 v32, v32, v33
    s_lshl_b32 s12, s5, 7
    v_lshlrev_b32 v10, 2, v5
    v_add_u32 v11, 0x22000, v10
    v_add_u32 v10, s12, v11
    ds_write_b32 v10, v32
    s_waitcnt lgkmcnt(0)
    s_barrier
    ds_read_b32 v32, v11 offset:0
    ds_read_b32 v33, v11 offset:128
    ds_read_b32 v34, v11 offset:256
    ds_read_b32 v35, v11 offset:384
    s_waitcnt lgkmcnt(0)
    v_max3_f32 v32, v32, v33, v34
    v_max_f32 v7, v32, v35
    v_mul_f32 v34, s47, v7
    v_sub_f32 v34, 0, v34
    v_fma_f32 v104, v104, s47, v34
    v_exp_f32 v104, v104
    v_fma_f32 v105, v105, s47, v34
    v_exp_f32 v105, v105
    v_fma_f32 v106, v106, s47, v34
    v_exp_f32 v106, v106
    v_fma_f32 v107, v107, s47, v34
    v_exp_f32 v107, v107
    v_fma_f32 v108, v108, s47, v34
    v_exp_f32 v108, v108
    v_fma_f32 v109, v109, s47, v34
    v_exp_f32 v109, v109
    v_fma_f32 v110, v110, s47, v34
    v_exp_f32 v110, v110
    v_fma_f32 v111, v111, s47, v34
    v_exp_f32 v111, v111
    v_fma_f32 v112, v112, s47, v34
    v_exp_f32 v112, v112
    v_fma_f32 v113, v113, s47, v34
    v_exp_f32 v113, v113
    v_fma_f32 v114, v114, s47, v34
    v_exp_f32 v114, v114
    v_fma_f32 v115, v115, s47, v34
    v_exp_f32 v115, v115
    v_fma_f32 v116, v116, s47, v34
    v_exp_f32 v116, v116
    v_fma_f32 v117, v117, s47, v34
    v_exp_f32 v117, v117
    v_fma_f32 v118, v118, s47, v34
    v_exp_f32 v118, v118
    v_fma_f32 v119, v119, s47, v34
    v_exp_f32 v119, v119
    s_nop 0
    v_add_f32 v8, v104, v105
    v_add_f32 v8, v8, v106
    v_add_f32 v8, v8, v107
    v_add_f32 v8, v8, v108
    v_add_f32 v8, v8, v109
    v_add_f32 v8, v8, v110
    v_add_f32 v8, v8, v111
    v_add_f32 v8, v8, v112
    v_add_f32 v8, v8, v113
    v_add_f32 v8, v8, v114
    v_add_f32 v8, v8, v115
    v_add_f32 v8, v8, v116
    v_add_f32 v8, v8, v117
    v_add_f32 v8, v8, v118
    v_add_f32 v8, v8, v119
    v_cvt_pk_bf16_f32 v120, v104, v105
    v_cvt_pk_bf16_f32 v121, v106, v107
    v_cvt_pk_bf16_f32 v122, v108, v109
    v_cvt_pk_bf16_f32 v123, v110, v111
    v_cvt_pk_bf16_f32 v124, v112, v113
    v_cvt_pk_bf16_f32 v125, v114, v115
    v_cvt_pk_bf16_f32 v126, v116, v117
    v_cvt_pk_bf16_f32 v127, v118, v119
    s_lshl_b32 s12, s5, 11
    s_add_u32 s12, s12, 0x20000
    v_add_u32 v10, s12, v12
    ds_write_b128 v10, v[120:123]
    ds_write_b128 v10, v[124:127] offset:1024
    s_lshl_b32 s12, s5, 8
    s_add_u32 s12, s12, 0x22400
    v_lshl_add_u32 v10, v2, 2, s12
    ds_write_b32 v10, v8
    s_waitcnt lgkmcnt(0)
    s_barrier
    v_add_u32 v10, 0x20000, v12
    ds_read_b128 v[32:35], v10 offset:0
    ds_read_b64_tr_b16 v[40:41], v24 offset:0
    ds_read_b64_tr_b16 v[42:43], v28 offset:8192
    ds_read_b64_tr_b16 v[44:45], v25 offset:0
    ds_read_b64_tr_b16 v[46:47], v29 offset:8192
    ds_read_b64_tr_b16 v[48:49], v26 offset:0
    ds_read_b64_tr_b16 v[50:51], v30 offset:8192
    ds_read_b64_tr_b16 v[52:53], v27 offset:0
    ds_read_b64_tr_b16 v[54:55], v31 offset:8192
    ds_read_b128 v[36:39], v10 offset:1024
    ds_read_b64_tr_b16 v[56:57], v24 offset:16384
    ds_read_b64_tr_b16 v[58:59], v28 offset:24576
    ds_read_b64_tr_b16 v[60:61], v25 offset:16384
    ds_read_b64_tr_b16 v[62:63], v29 offset:24576
    ds_read_b64_tr_b16 v[64:65], v26 offset:16384
    ds_read_b64_tr_b16 v[66:67], v30 offset:24576
    ds_read_b64_tr_b16 v[68:69], v27 offset:16384
    ds_read_b64_tr_b16 v[70:71], v31 offset:24576
    s_waitcnt lgkmcnt(9)
    v_mfma_f32_32x32x16_bf16 a[192:207], v[32:35], v[40:43], 0
    v_mfma_f32_32x32x16_bf16 a[208:223], v[32:35], v[44:47], 0
    v_mfma_f32_32x32x16_bf16 a[224:239], v[32:35], v[48:51], 0
    v_mfma_f32_32x32x16_bf16 a[240:255], v[32:35], v[52:55], 0
    ds_read_b128 v[32:35], v10 offset:2048
    ds_read_b64_tr_b16 v[40:41], v24 offset:32768
    ds_read_b64_tr_b16 v[42:43], v28 offset:40960
    ds_read_b64_tr_b16 v[44:45], v25 offset:32768
    ds_read_b64_tr_b16 v[46:47], v29 offset:40960
    ds_read_b64_tr_b16 v[48:49], v26 offset:32768
    ds_read_b64_tr_b16 v[50:51], v30 offset:40960
    ds_read_b64_tr_b16 v[52:53], v27 offset:32768
    ds_read_b64_tr_b16 v[54:55], v31 offset:40960
    s_waitcnt lgkmcnt(9)
    v_mfma_f32_32x32x16_bf16 a[192:207], v[36:39], v[56:59], a[192:207]
    v_mfma_f32_32x32x16_bf16 a[208:223], v[36:39], v[60:63], a[208:223]
    v_mfma_f32_32x32x16_bf16 a[224:239], v[36:39], v[64:67], a[224:239]
    v_mfma_f32_32x32x16_bf16 a[240:255], v[36:39], v[68:71], a[240:255]
    ds_read_b128 v[36:39], v10 offset:3072
    ds_read_b64_tr_b16 v[56:57], v24 offset:49152
    ds_read_b64_tr_b16 v[58:59], v28 offset:57344
    ds_read_b64_tr_b16 v[60:61], v25 offset:49152
    ds_read_b64_tr_b16 v[62:63], v29 offset:57344
    ds_read_b64_tr_b16 v[64:65], v26 offset:49152
    ds_read_b64_tr_b16 v[66:67], v30 offset:57344
    ds_read_b64_tr_b16 v[68:69], v27 offset:49152
    ds_read_b64_tr_b16 v[70:71], v31 offset:57344
    s_waitcnt lgkmcnt(9)
    v_mfma_f32_32x32x16_bf16 a[192:207], v[32:35], v[40:43], a[192:207]
    v_mfma_f32_32x32x16_bf16 a[208:223], v[32:35], v[44:47], a[208:223]
    v_mfma_f32_32x32x16_bf16 a[224:239], v[32:35], v[48:51], a[224:239]
    v_mfma_f32_32x32x16_bf16 a[240:255], v[32:35], v[52:55], a[240:255]
    ds_read_b128 v[32:35], v10 offset:4096
    ds_read_b64_tr_b16 v[40:41], v96 offset:0
    ds_read_b64_tr_b16 v[42:43], v100 offset:8192
    ds_read_b64_tr_b16 v[44:45], v97 offset:0
    ds_read_b64_tr_b16 v[46:47], v101 offset:8192
    ds_read_b64_tr_b16 v[48:49], v98 offset:0
    ds_read_b64_tr_b16 v[50:51], v102 offset:8192
    ds_read_b64_tr_b16 v[52:53], v99 offset:0
    ds_read_b64_tr_b16 v[54:55], v103 offset:8192
    s_waitcnt lgkmcnt(9)
    v_mfma_f32_32x32x16_bf16 a[192:207], v[36:39], v[56:59], a[192:207]
    v_mfma_f32_32x32x16_bf16 a[208:223], v[36:39], v[60:63], a[208:223]
    v_mfma_f32_32x32x16_bf16 a[224:239], v[36:39], v[64:67], a[224:239]
    v_mfma_f32_32x32x16_bf16 a[240:255], v[36:39], v[68:71], a[240:255]
    ds_read_b128 v[36:39], v10 offset:5120
    ds_read_b64_tr_b16 v[56:57], v96 offset:16384
    ds_read_b64_tr_b16 v[58:59], v100 offset:24576
    ds_read_b64_tr_b16 v[60:61], v97 offset:16384
    ds_read_b64_tr_b16 v[62:63], v101 offset:24576
    ds_read_b64_tr_b16 v[64:65], v98 offset:16384
    ds_read_b64_tr_b16 v[66:67], v102 offset:24576
    ds_read_b64_tr_b16 v[68:69], v99 offset:16384
    ds_read_b64_tr_b16 v[70:71], v103 offset:24576
    s_waitcnt lgkmcnt(9)
    v_mfma_f32_32x32x16_bf16 a[192:207], v[32:35], v[40:43], a[192:207]
    v_mfma_f32_32x32x16_bf16 a[208:223], v[32:35], v[44:47], a[208:223]
    v_mfma_f32_32x32x16_bf16 a[224:239], v[32:35], v[48:51], a[224:239]
    v_mfma_f32_32x32x16_bf16 a[240:255], v[32:35], v[52:55], a[240:255]
    ds_read_b128 v[32:35], v10 offset:6144
    ds_read_b64_tr_b16 v[40:41], v96 offset:32768
    ds_read_b64_tr_b16 v[42:43], v100 offset:40960
    ds_read_b64_tr_b16 v[44:45], v97 offset:32768
    ds_read_b64_tr_b16 v[46:47], v101 offset:40960
    ds_read_b64_tr_b16 v[48:49], v98 offset:32768
    ds_read_b64_tr_b16 v[50:51], v102 offset:40960
    ds_read_b64_tr_b16 v[52:53], v99 offset:32768
    ds_read_b64_tr_b16 v[54:55], v103 offset:40960
    s_waitcnt lgkmcnt(9)
    v_mfma_f32_32x32x16_bf16 a[192:207], v[36:39], v[56:59], a[192:207]
    v_mfma_f32_32x32x16_bf16 a[208:223], v[36:39], v[60:63], a[208:223]
    v_mfma_f32_32x32x16_bf16 a[224:239], v[36:39], v[64:67], a[224:239]
    v_mfma_f32_32x32x16_bf16 a[240:255], v[36:39], v[68:71], a[240:255]
    ds_read_b128 v[36:39], v10 offset:7168
    ds_read_b64_tr_b16 v[56:57], v96 offset:49152
    ds_read_b64_tr_b16 v[58:59], v100 offset:57344
    ds_read_b64_tr_b16 v[60:61], v97 offset:49152
    ds_read_b64_tr_b16 v[62:63], v101 offset:57344
    ds_read_b64_tr_b16 v[64:65], v98 offset:49152
    ds_read_b64_tr_b16 v[66:67], v102 offset:57344
    ds_read_b64_tr_b16 v[68:69], v99 offset:49152
    ds_read_b64_tr_b16 v[70:71], v103 offset:57344
    s_waitcnt lgkmcnt(9)
    v_mfma_f32_32x32x16_bf16 a[192:207], v[32:35], v[40:43], a[192:207]
    v_mfma_f32_32x32x16_bf16 a[208:223], v[32:35], v[44:47], a[208:223]
    v_mfma_f32_32x32x16_bf16 a[224:239], v[32:35], v[48:51], a[224:239]
    v_mfma_f32_32x32x16_bf16 a[240:255], v[32:35], v[52:55], a[240:255]
    s_waitcnt lgkmcnt(0)
    v_mfma_f32_32x32x16_bf16 a[192:207], v[36:39], v[56:59], a[192:207]
    v_mfma_f32_32x32x16_bf16 a[208:223], v[36:39], v[60:63], a[208:223]
    v_mfma_f32_32x32x16_bf16 a[224:239], v[36:39], v[64:67], a[224:239]
    v_mfma_f32_32x32x16_bf16 a[240:255], v[36:39], v[68:71], a[240:255]
    s_lshl_b32 s12, s9, 15
    s_add_u32 s12, s12, 0x100000
    s_lshl_b32 s13, s5, 8
    s_add_u32 s12, s12, s13
    v_lshlrev_b32 v10, 12, v6
    v_lshl_add_u32 v10, v5, 2, v10
    s_nop 7
    s_nop 3
    s_add_u32 s13, s12, 0
    v_accvgpr_read_b32 v32, a192
    v_accvgpr_read_b32 v33, a208
    v_cvt_pk_bf16_f32 v32, v32, v33
    buffer_store_dword v32, v10, s[64:67], s13 offen offset:0 sc1
    v_accvgpr_read_b32 v34, a224
    v_accvgpr_read_b32 v35, a240
    v_cvt_pk_bf16_f32 v34, v34, v35
    buffer_store_dword v34, v10, s[64:67], s13 offen offset:128 sc1
    s_add_u32 s13, s12, 1024
    v_accvgpr_read_b32 v36, a193
    v_accvgpr_read_b32 v37, a209
    v_cvt_pk_bf16_f32 v36, v36, v37
    buffer_store_dword v36, v10, s[64:67], s13 offen offset:0 sc1
    v_accvgpr_read_b32 v38, a225
    v_accvgpr_read_b32 v39, a241
    v_cvt_pk_bf16_f32 v38, v38, v39
    buffer_store_dword v38, v10, s[64:67], s13 offen offset:128 sc1
    s_add_u32 s13, s12, 2048
    v_accvgpr_read_b32 v40, a194
    v_accvgpr_read_b32 v41, a210
    v_cvt_pk_bf16_f32 v40, v40, v41
    buffer_store_dword v40, v10, s[64:67], s13 offen offset:0 sc1
    v_accvgpr_read_b32 v42, a226
    v_accvgpr_read_b32 v43, a242
    v_cvt_pk_bf16_f32 v42, v42, v43
    buffer_store_dword v42, v10, s[64:67], s13 offen offset:128 sc1
    s_add_u32 s13, s12, 3072
    v_accvgpr_read_b32 v44, a195
    v_accvgpr_read_b32 v45, a211
    v_cvt_pk_bf16_f32 v44, v44, v45
    buffer_store_dword v44, v10, s[64:67], s13 offen offset:0 sc1
    v_accvgpr_read_b32 v46, a227
    v_accvgpr_read_b32 v47, a243
    v_cvt_pk_bf16_f32 v46, v46, v47
    buffer_store_dword v46, v10, s[64:67], s13 offen offset:128 sc1
    s_add_u32 s13, s12, 8192
    v_accvgpr_read_b32 v32, a196
    v_accvgpr_read_b32 v33, a212
    v_cvt_pk_bf16_f32 v32, v32, v33
    buffer_store_dword v32, v10, s[64:67], s13 offen offset:0 sc1
    v_accvgpr_read_b32 v34, a228
    v_accvgpr_read_b32 v35, a244
    v_cvt_pk_bf16_f32 v34, v34, v35
    buffer_store_dword v34, v10, s[64:67], s13 offen offset:128 sc1
    s_add_u32 s13, s12, 9216
    v_accvgpr_read_b32 v36, a197
    v_accvgpr_read_b32 v37, a213
    v_cvt_pk_bf16_f32 v36, v36, v37
    buffer_store_dword v36, v10, s[64:67], s13 offen offset:0 sc1
    v_accvgpr_read_b32 v38, a229
    v_accvgpr_read_b32 v39, a245
    v_cvt_pk_bf16_f32 v38, v38, v39
    buffer_store_dword v38, v10, s[64:67], s13 offen offset:128 sc1
    s_add_u32 s13, s12, 10240
    v_accvgpr_read_b32 v40, a198
    v_accvgpr_read_b32 v41, a214
    v_cvt_pk_bf16_f32 v40, v40, v41
    buffer_store_dword v40, v10, s[64:67], s13 offen offset:0 sc1
    v_accvgpr_read_b32 v42, a230
    v_accvgpr_read_b32 v43, a246
    v_cvt_pk_bf16_f32 v42, v42, v43
    buffer_store_dword v42, v10, s[64:67], s13 offen offset:128 sc1
    s_add_u32 s13, s12, 11264
    v_accvgpr_read_b32 v44, a199
    v_accvgpr_read_b32 v45, a215
    v_cvt_pk_bf16_f32 v44, v44, v45
    buffer_store_dword v44, v10, s[64:67], s13 offen offset:0 sc1
    v_accvgpr_read_b32 v46, a231
    v_accvgpr_read_b32 v47, a247
    v_cvt_pk_bf16_f32 v46, v46, v47
    buffer_store_dword v46, v10, s[64:67], s13 offen offset:128 sc1
    s_add_u32 s13, s12, 16384
    v_accvgpr_read_b32 v32, a200
    v_accvgpr_read_b32 v33, a216
    v_cvt_pk_bf16_f32 v32, v32, v33
    buffer_store_dword v32, v10, s[64:67], s13 offen offset:0 sc1
    v_accvgpr_read_b32 v34, a232
    v_accvgpr_read_b32 v35, a248
    v_cvt_pk_bf16_f32 v34, v34, v35
    buffer_store_dword v34, v10, s[64:67], s13 offen offset:128 sc1
    s_add_u32 s13, s12, 17408
    v_accvgpr_read_b32 v36, a201
    v_accvgpr_read_b32 v37, a217
    v_cvt_pk_bf16_f32 v36, v36, v37
    buffer_store_dword v36, v10, s[64:67], s13 offen offset:0 sc1
    v_accvgpr_read_b32 v38, a233
    v_accvgpr_read_b32 v39, a249
    v_cvt_pk_bf16_f32 v38, v38, v39
    buffer_store_dword v38, v10, s[64:67], s13 offen offset:128 sc1
    s_add_u32 s13, s12, 18432
    v_accvgpr_read_b32 v40, a202
    v_accvgpr_read_b32 v41, a218
    v_cvt_pk_bf16_f32 v40, v40, v41
    buffer_store_dword v40, v10, s[64:67], s13 offen offset:0 sc1
    v_accvgpr_read_b32 v42, a234
    v_accvgpr_read_b32 v43, a250
    v_cvt_pk_bf16_f32 v42, v42, v43
    buffer_store_dword v42, v10, s[64:67], s13 offen offset:128 sc1
    s_add_u32 s13, s12, 19456
    v_accvgpr_read_b32 v44, a203
    v_accvgpr_read_b32 v45, a219
    v_cvt_pk_bf16_f32 v44, v44, v45
    buffer_store_dword v44, v10, s[64:67], s13 offen offset:0 sc1
    v_accvgpr_read_b32 v46, a235
    v_accvgpr_read_b32 v47, a251
    v_cvt_pk_bf16_f32 v46, v46, v47
    buffer_store_dword v46, v10, s[64:67], s13 offen offset:128 sc1
    s_add_u32 s13, s12, 24576
    v_accvgpr_read_b32 v32, a204
    v_accvgpr_read_b32 v33, a220
    v_cvt_pk_bf16_f32 v32, v32, v33
    buffer_store_dword v32, v10, s[64:67], s13 offen offset:0 sc1
    v_accvgpr_read_b32 v34, a236
    v_accvgpr_read_b32 v35, a252
    v_cvt_pk_bf16_f32 v34, v34, v35
    buffer_store_dword v34, v10, s[64:67], s13 offen offset:128 sc1
    s_add_u32 s13, s12, 25600
    v_accvgpr_read_b32 v36, a205
    v_accvgpr_read_b32 v37, a221
    v_cvt_pk_bf16_f32 v36, v36, v37
    buffer_store_dword v36, v10, s[64:67], s13 offen offset:0 sc1
    v_accvgpr_read_b32 v38, a237
    v_accvgpr_read_b32 v39, a253
    v_cvt_pk_bf16_f32 v38, v38, v39
    buffer_store_dword v38, v10, s[64:67], s13 offen offset:128 sc1
    s_add_u32 s13, s12, 26624
    v_accvgpr_read_b32 v40, a206
    v_accvgpr_read_b32 v41, a222
    v_cvt_pk_bf16_f32 v40, v40, v41
    buffer_store_dword v40, v10, s[64:67], s13 offen offset:0 sc1
    v_accvgpr_read_b32 v42, a238
    v_accvgpr_read_b32 v43, a254
    v_cvt_pk_bf16_f32 v42, v42, v43
    buffer_store_dword v42, v10, s[64:67], s13 offen offset:128 sc1
    s_add_u32 s13, s12, 27648
    v_accvgpr_read_b32 v44, a207
    v_accvgpr_read_b32 v45, a223
    v_cvt_pk_bf16_f32 v44, v44, v45
    buffer_store_dword v44, v10, s[64:67], s13 offen offset:0 sc1
    v_accvgpr_read_b32 v46, a239
    v_accvgpr_read_b32 v47, a255
    v_cvt_pk_bf16_f32 v46, v46, v47
    buffer_store_dword v46, v10, s[64:67], s13 offen offset:128 sc1
    s_cmp_lg_u32 s5, 0
    s_cbranch_scc1 K1A_ML1
    v_cmp_gt_u32 vcc, 32, v2
    s_and_saveexec_b64 s[68:69], vcc
    v_lshlrev_b32 v10, 2, v2
    v_add_u32 v10, 0x22400, v10
    ds_read_b32 v64, v10 offset:0
    ds_read_b32 v65, v10 offset:128
    ds_read_b32 v66, v10 offset:256
    ds_read_b32 v67, v10 offset:384
    ds_read_b32 v68, v10 offset:512
    ds_read_b32 v69, v10 offset:640
    ds_read_b32 v70, v10 offset:768
    ds_read_b32 v71, v10 offset:896
    s_waitcnt lgkmcnt(0)
    v_add_f32 v64, v64, v65
    v_add_f32 v64, v64, v66
    v_add_f32 v64, v64, v67
    v_add_f32 v64, v64, v68
    v_add_f32 v64, v64, v69
    v_add_f32 v64, v64, v70
    v_add_f32 v64, v64, v71
    v_mov_b32 v65, v64
    v_mov_b32 v64, v7
    s_lshl_b32 s12, s9, 8
    s_add_u32 s12, s12, 0x10000
    v_lshlrev_b32 v10, 3, v2
    buffer_store_dwordx2 v[64:65], v10, s[64:67], s12 offen sc1
    s_mov_b64 exec, s[68:69]
K1A_ML1:
    s_lshl_b32 s71, s10, 2
    s_waitcnt vmcnt(0)
    s_barrier
    s_cmp_lg_u32 s5, 0
    s_cbranch_scc1 K1A_S2_S
    v_mov_b32 v11, 1
    s_mov_b64 exec, 1
    buffer_atomic_add v11, off, s[72:75], s71 offset:64 sc1
    s_mov_b64 exec, -1
K1A_S2_S:
    buffer_load_dwordx4 v[128:131], v12, s[80:83], s84 offen nt
    s_add_u32 s84, s84, 1024
    buffer_load_dwordx4 v[132:135], v12, s[80:83], s84 offen nt
    s_add_u32 s84, s84, 1024
    buffer_load_dwordx4 v[136:139], v12, s[80:83], s84 offen nt
    s_add_u32 s84, s84, 1024
    buffer_load_dwordx4 v[140:143], v12, s[80:83], s84 offen nt
    s_add_u32 s84, s84, 1024
    buffer_load_dwordx4 v[144:147], v12, s[80:83], s84 offen nt
    s_add_u32 s84, s84, 1024
    buffer_load_dwordx4 v[148:151], v12, s[80:83], s84 offen nt
    s_add_u32 s84, s84, 1024
    buffer_load_dwordx4 v[152:155], v12, s[80:83], s84 offen nt
    s_add_u32 s84, s84, 1024
    buffer_load_dwordx4 v[156:159], v12, s[80:83], s84 offen nt
    s_add_u32 s84, s84, 1024
    buffer_load_dwordx4 v[160:163], v12, s[80:83], s84 offen nt
    s_add_u32 s84, s84, 1024
    buffer_load_dwordx4 v[164:167], v12, s[80:83], s84 offen nt
    s_add_u32 s84, s84, 1024
    buffer_load_dwordx4 v[168:171], v12, s[80:83], s84 offen nt
    s_add_u32 s84, s84, 1024
    buffer_load_dwordx4 v[172:175], v12, s[80:83], s84 offen nt
    s_add_u32 s84, s84, 1024
    buffer_load_dwordx4 v[176:179], v12, s[80:83], s84 offen nt
    s_add_u32 s84, s84, 1024
    buffer_load_dwordx4 v[180:183], v12, s[80:83], s84 offen nt
    s_add_u32 s84, s84, 1024
    buffer_load_dwordx4 v[184:187], v12, s[80:83], s84 offen nt
    s_add_u32 s84, s84, 1024
    buffer_load_dwordx4 v[188:191], v12, s[80:83], s84 offen nt
    s_add_u32 s84, s84, 1024
    s_lshl_b32 s71, s14, 2
    s_cmp_lg_u32 s5, 0
    s_cbranch_scc1 K1A_P2_OK
K1A_P2_L:
    buffer_load_dword v11, off, s[72:75], s71 offset:64 sc1
    s_waitcnt vmcnt(0)
    v_readfirstlane_b32 s13, v11
    s_cmp_ge_u32 s13, 64
    s_cbranch_scc1 K1A_P2_OK
    s_sleep 1
    s_branch K1A_P2_L
K1A_P2_OK:
    s_barrier
    v_lshlrev_b32 v10, 8, v2
    s_lshl_b32 s6, s7, 3
    s_lshl_b32 s13, s14, 14
    s_add_u32 s6, s6, s13
    s_add_u32 s6, s6, 0x10000
    buffer_load_dwordx2 v[16:17], v10, s[64:67], s6 offen sc1
    s_lshl_b32 s6, s7, 10
    s_lshl_b32 s13, s5, 19
    s_add_u32 s6, s6, s13
    s_lshl_b32 s13, s14, 21
    s_add_u32 s6, s6, s13
    s_add_u32 s6, s6, 0x100000
    buffer_load_dwordx4 v[64:67], v12, s[64:67], s6 offen sc1
    s_add_u32 s6, s6, 32768
    buffer_load_dwordx4 v[68:71], v12, s[64:67], s6 offen sc1
    s_add_u32 s6, s6, 32768
    buffer_load_dwordx4 v[72:75], v12, s[64:67], s6 offen sc1
    s_add_u32 s6, s6, 32768
    buffer_load_dwordx4 v[76:79], v12, s[64:67], s6 offen sc1
    s_add_u32 s6, s6, 32768
    buffer_load_dwordx4 v[80:83], v12, s[64:67], s6 offen sc1
    s_add_u32 s6, s6, 32768
    buffer_load_dwordx4 v[84:87], v12, s[64:67], s6 offen sc1
    s_add_u32 s6, s6, 32768
    buffer_load_dwordx4 v[88:91], v12, s[64:67], s6 offen sc1
    s_add_u32 s6, s6, 32768
    buffer_load_dwordx4 v[92:95], v12, s[64:67], s6 offen sc1
    s_add_u32 s6, s6, 32768
    buffer_load_dwordx4 v[96:99], v12, s[64:67], s6 offen sc1
    s_add_u32 s6, s6, 32768
    buffer_load_dwordx4 v[100:103], v12, s[64:67], s6 offen sc1
    s_add_u32 s6, s6, 32768
    buffer_load_dwordx4 v[104:107], v12, s[64:67], s6 offen sc1
    s_add_u32 s6, s6, 32768
    buffer_load_dwordx4 v[108:111], v12, s[64:67], s6 offen sc1
    s_add_u32 s6, s6, 32768
    buffer_load_dwordx4 v[112:115], v12, s[64:67], s6 offen sc1
    s_add_u32 s6, s6, 32768
    buffer_load_dwordx4 v[116:119], v12, s[64:67], s6 offen sc1
    s_add_u32 s6, s6, 32768
    buffer_load_dwordx4 v[120:123], v12, s[64:67], s6 offen sc1
    s_add_u32 s6, s6, 32768
    buffer_load_dwordx4 v[124:127], v12, s[64:67], s6 offen sc1
    s_add_u32 s6, s6, 32768
    s_waitcnt vmcnt(16)
    v_mov_b32 v18, v16
    s_nop 1
    v_max_f32_dpp v18, v18, v18 row_ror:1 row_mask:0xf bank_mask:0xf
    s_nop 1
    v_max_f32_dpp v18, v18, v18 row_ror:2 row_mask:0xf bank_mask:0xf
    s_nop 1
    v_max_f32_dpp v18, v18, v18 row_ror:4 row_mask:0xf bank_mask:0xf
    s_nop 1
    v_max_f32_dpp v18, v18, v18 row_ror:8 row_mask:0xf bank_mask:0xf
    v_mov_b32 v19, v18
    s_nop 1
    v_permlane16_swap_b32 v18, v19
    s_nop 1
    v_max_f32 v18, v18, v19
    v_mov_b32 v19, v18
    s_nop 1
    v_permlane32_swap_b32 v18, v19
    s_nop 1
    v_max_f32 v18, v18, v19
    v_sub_f32 v16, v16, v18
    v_mul_f32 v16, s47, v16
    v_exp_f32 v16, v16
    s_nop 0
    v_mul_f32 v17, v17, v16
    s_nop 1
    v_add_f32_dpp v17, v17, v17 row_ror:1 row_mask:0xf bank_mask:0xf
    s_nop 1
    v_add_f32_dpp v17, v17, v17 row_ror:2 row_mask:0xf bank_mask:0xf
    s_nop 1
    v_add_f32_dpp v17, v17, v17 row_ror:4 row_mask:0xf bank_mask:0xf
    s_nop 1
    v_add_f32_dpp v17, v17, v17 row_ror:8 row_mask:0xf bank_mask:0xf
    v_mov_b32 v19, v17
    s_nop 1
    v_permlane16_swap_b32 v17, v19
    s_nop 1
    v_add_f32 v17, v17, v19
    v_mov_b32 v19, v17
    s_nop 1
    v_permlane32_swap_b32 v17, v19
    s_nop 1
    v_add_f32 v17, v17, v19
    v_rcp_f32 v17, v17
    s_nop 0
    v_mul_f32 v16, v16, v17
    v_mov_b32 v24, 0
    v_mov_b32 v25, 0
    v_mov_b32 v26, 0
    v_mov_b32 v27, 0
    v_mov_b32 v28, 0
    v_mov_b32 v29, 0
    v_mov_b32 v30, 0
    v_mov_b32 v31, 0
    s_lshl_b32 s6, s5, 4
    s_add_u32 s13, s6, 0
    v_readlane_b32 s12, v16, s13
    s_waitcnt vmcnt(15)
    v_lshlrev_b32 v32, 16, v64
    v_and_b32 v36, s46, v64
    v_lshlrev_b32 v33, 16, v65
    v_and_b32 v37, s46, v65
    v_lshlrev_b32 v34, 16, v66
    v_and_b32 v38, s46, v66
    v_lshlrev_b32 v35, 16, v67
    v_and_b32 v39, s46, v67
    v_fmac_f32 v24, s12, v32
    v_fmac_f32 v28, s12, v36
    v_fmac_f32 v25, s12, v33
    v_fmac_f32 v29, s12, v37
    v_fmac_f32 v26, s12, v34
    v_fmac_f32 v30, s12, v38
    v_fmac_f32 v27, s12, v35
    v_fmac_f32 v31, s12, v39
    s_add_u32 s13, s6, 1
    v_readlane_b32 s12, v16, s13
    s_waitcnt vmcnt(14)
    v_lshlrev_b32 v32, 16, v68
    v_and_b32 v36, s46, v68
    v_lshlrev_b32 v33, 16, v69
    v_and_b32 v37, s46, v69
    v_lshlrev_b32 v34, 16, v70
    v_and_b32 v38, s46, v70
    v_lshlrev_b32 v35, 16, v71
    v_and_b32 v39, s46, v71
    v_fmac_f32 v24, s12, v32
    v_fmac_f32 v28, s12, v36
    v_fmac_f32 v25, s12, v33
    v_fmac_f32 v29, s12, v37
    v_fmac_f32 v26, s12, v34
    v_fmac_f32 v30, s12, v38
    v_fmac_f32 v27, s12, v35
    v_fmac_f32 v31, s12, v39
    s_add_u32 s13, s6, 2
    v_readlane_b32 s12, v16, s13
    s_waitcnt vmcnt(13)
    v_lshlrev_b32 v32, 16, v72
    v_and_b32 v36, s46, v72
    v_lshlrev_b32 v33, 16, v73
    v_and_b32 v37, s46, v73
    v_lshlrev_b32 v34, 16, v74
    v_and_b32 v38, s46, v74
    v_lshlrev_b32 v35, 16, v75
    v_and_b32 v39, s46, v75
    v_fmac_f32 v24, s12, v32
    v_fmac_f32 v28, s12, v36
    v_fmac_f32 v25, s12, v33
    v_fmac_f32 v29, s12, v37
    v_fmac_f32 v26, s12, v34
    v_fmac_f32 v30, s12, v38
    v_fmac_f32 v27, s12, v35
    v_fmac_f32 v31, s12, v39
    s_add_u32 s13, s6, 3
    v_readlane_b32 s12, v16, s13
    s_waitcnt vmcnt(12)
    v_lshlrev_b32 v32, 16, v76
    v_and_b32 v36, s46, v76
    v_lshlrev_b32 v33, 16, v77
    v_and_b32 v37, s46, v77
    v_lshlrev_b32 v34, 16, v78
    v_and_b32 v38, s46, v78
    v_lshlrev_b32 v35, 16, v79
    v_and_b32 v39, s46, v79
    v_fmac_f32 v24, s12, v32
    v_fmac_f32 v28, s12, v36
    v_fmac_f32 v25, s12, v33
    v_fmac_f32 v29, s12, v37
    v_fmac_f32 v26, s12, v34
    v_fmac_f32 v30, s12, v38
    v_fmac_f32 v27, s12, v35
    v_fmac_f32 v31, s12, v39
    s_add_u32 s13, s6, 4
    v_readlane_b32 s12, v16, s13
    s_waitcnt vmcnt(11)
    v_lshlrev_b32 v32, 16, v80
    v_and_b32 v36, s46, v80
    v_lshlrev_b32 v33, 16, v81
    v_and_b32 v37, s46, v81
    v_lshlrev_b32 v34, 16, v82
    v_and_b32 v38, s46, v82
    v_lshlrev_b32 v35, 16, v83
    v_and_b32 v39, s46, v83
    v_fmac_f32 v24, s12, v32
    v_fmac_f32 v28, s12, v36
    v_fmac_f32 v25, s12, v33
    v_fmac_f32 v29, s12, v37
    v_fmac_f32 v26, s12, v34
    v_fmac_f32 v30, s12, v38
    v_fmac_f32 v27, s12, v35
    v_fmac_f32 v31, s12, v39
    s_add_u32 s13, s6, 5
    v_readlane_b32 s12, v16, s13
    s_waitcnt vmcnt(10)
    v_lshlrev_b32 v32, 16, v84
    v_and_b32 v36, s46, v84
    v_lshlrev_b32 v33, 16, v85
    v_and_b32 v37, s46, v85
    v_lshlrev_b32 v34, 16, v86
    v_and_b32 v38, s46, v86
    v_lshlrev_b32 v35, 16, v87
    v_and_b32 v39, s46, v87
    v_fmac_f32 v24, s12, v32
    v_fmac_f32 v28, s12, v36
    v_fmac_f32 v25, s12, v33
    v_fmac_f32 v29, s12, v37
    v_fmac_f32 v26, s12, v34
    v_fmac_f32 v30, s12, v38
    v_fmac_f32 v27, s12, v35
    v_fmac_f32 v31, s12, v39
    s_add_u32 s13, s6, 6
    v_readlane_b32 s12, v16, s13
    s_waitcnt vmcnt(9)
    v_lshlrev_b32 v32, 16, v88
    v_and_b32 v36, s46, v88
    v_lshlrev_b32 v33, 16, v89
    v_and_b32 v37, s46, v89
    v_lshlrev_b32 v34, 16, v90
    v_and_b32 v38, s46, v90
    v_lshlrev_b32 v35, 16, v91
    v_and_b32 v39, s46, v91
    v_fmac_f32 v24, s12, v32
    v_fmac_f32 v28, s12, v36
    v_fmac_f32 v25, s12, v33
    v_fmac_f32 v29, s12, v37
    v_fmac_f32 v26, s12, v34
    v_fmac_f32 v30, s12, v38
    v_fmac_f32 v27, s12, v35
    v_fmac_f32 v31, s12, v39
    s_add_u32 s13, s6, 7
    v_readlane_b32 s12, v16, s13
    s_waitcnt vmcnt(8)
    v_lshlrev_b32 v32, 16, v92
    v_and_b32 v36, s46, v92
    v_lshlrev_b32 v33, 16, v93
    v_and_b32 v37, s46, v93
    v_lshlrev_b32 v34, 16, v94
    v_and_b32 v38, s46, v94
    v_lshlrev_b32 v35, 16, v95
    v_and_b32 v39, s46, v95
    v_fmac_f32 v24, s12, v32
    v_fmac_f32 v28, s12, v36
    v_fmac_f32 v25, s12, v33
    v_fmac_f32 v29, s12, v37
    v_fmac_f32 v26, s12, v34
    v_fmac_f32 v30, s12, v38
    v_fmac_f32 v27, s12, v35
    v_fmac_f32 v31, s12, v39
    s_add_u32 s13, s6, 8
    v_readlane_b32 s12, v16, s13
    s_waitcnt vmcnt(7)
    v_lshlrev_b32 v32, 16, v96
    v_and_b32 v36, s46, v96
    v_lshlrev_b32 v33, 16, v97
    v_and_b32 v37, s46, v97
    v_lshlrev_b32 v34, 16, v98
    v_and_b32 v38, s46, v98
    v_lshlrev_b32 v35, 16, v99
    v_and_b32 v39, s46, v99
    v_fmac_f32 v24, s12, v32
    v_fmac_f32 v28, s12, v36
    v_fmac_f32 v25, s12, v33
    v_fmac_f32 v29, s12, v37
    v_fmac_f32 v26, s12, v34
    v_fmac_f32 v30, s12, v38
    v_fmac_f32 v27, s12, v35
    v_fmac_f32 v31, s12, v39
    s_add_u32 s13, s6, 9
    v_readlane_b32 s12, v16, s13
    s_waitcnt vmcnt(6)
    v_lshlrev_b32 v32, 16, v100
    v_and_b32 v36, s46, v100
    v_lshlrev_b32 v33, 16, v101
    v_and_b32 v37, s46, v101
    v_lshlrev_b32 v34, 16, v102
    v_and_b32 v38, s46, v102
    v_lshlrev_b32 v35, 16, v103
    v_and_b32 v39, s46, v103
    v_fmac_f32 v24, s12, v32
    v_fmac_f32 v28, s12, v36
    v_fmac_f32 v25, s12, v33
    v_fmac_f32 v29, s12, v37
    v_fmac_f32 v26, s12, v34
    v_fmac_f32 v30, s12, v38
    v_fmac_f32 v27, s12, v35
    v_fmac_f32 v31, s12, v39
    s_add_u32 s13, s6, 10
    v_readlane_b32 s12, v16, s13
    s_waitcnt vmcnt(5)
    v_lshlrev_b32 v32, 16, v104
    v_and_b32 v36, s46, v104
    v_lshlrev_b32 v33, 16, v105
    v_and_b32 v37, s46, v105
    v_lshlrev_b32 v34, 16, v106
    v_and_b32 v38, s46, v106
    v_lshlrev_b32 v35, 16, v107
    v_and_b32 v39, s46, v107
    v_fmac_f32 v24, s12, v32
    v_fmac_f32 v28, s12, v36
    v_fmac_f32 v25, s12, v33
    v_fmac_f32 v29, s12, v37
    v_fmac_f32 v26, s12, v34
    v_fmac_f32 v30, s12, v38
    v_fmac_f32 v27, s12, v35
    v_fmac_f32 v31, s12, v39
    s_add_u32 s13, s6, 11
    v_readlane_b32 s12, v16, s13
    s_waitcnt vmcnt(4)
    v_lshlrev_b32 v32, 16, v108
    v_and_b32 v36, s46, v108
    v_lshlrev_b32 v33, 16, v109
    v_and_b32 v37, s46, v109
    v_lshlrev_b32 v34, 16, v110
    v_and_b32 v38, s46, v110
    v_lshlrev_b32 v35, 16, v111
    v_and_b32 v39, s46, v111
    v_fmac_f32 v24, s12, v32
    v_fmac_f32 v28, s12, v36
    v_fmac_f32 v25, s12, v33
    v_fmac_f32 v29, s12, v37
    v_fmac_f32 v26, s12, v34
    v_fmac_f32 v30, s12, v38
    v_fmac_f32 v27, s12, v35
    v_fmac_f32 v31, s12, v39
    s_add_u32 s13, s6, 12
    v_readlane_b32 s12, v16, s13
    s_waitcnt vmcnt(3)
    v_lshlrev_b32 v32, 16, v112
    v_and_b32 v36, s46, v112
    v_lshlrev_b32 v33, 16, v113
    v_and_b32 v37, s46, v113
    v_lshlrev_b32 v34, 16, v114
    v_and_b32 v38, s46, v114
    v_lshlrev_b32 v35, 16, v115
    v_and_b32 v39, s46, v115
    v_fmac_f32 v24, s12, v32
    v_fmac_f32 v28, s12, v36
    v_fmac_f32 v25, s12, v33
    v_fmac_f32 v29, s12, v37
    v_fmac_f32 v26, s12, v34
    v_fmac_f32 v30, s12, v38
    v_fmac_f32 v27, s12, v35
    v_fmac_f32 v31, s12, v39
    s_add_u32 s13, s6, 13
    v_readlane_b32 s12, v16, s13
    s_waitcnt vmcnt(2)
    v_lshlrev_b32 v32, 16, v116
    v_and_b32 v36, s46, v116
    v_lshlrev_b32 v33, 16, v117
    v_and_b32 v37, s46, v117
    v_lshlrev_b32 v34, 16, v118
    v_and_b32 v38, s46, v118
    v_lshlrev_b32 v35, 16, v119
    v_and_b32 v39, s46, v119
    v_fmac_f32 v24, s12, v32
    v_fmac_f32 v28, s12, v36
    v_fmac_f32 v25, s12, v33
    v_fmac_f32 v29, s12, v37
    v_fmac_f32 v26, s12, v34
    v_fmac_f32 v30, s12, v38
    v_fmac_f32 v27, s12, v35
    v_fmac_f32 v31, s12, v39
    s_add_u32 s13, s6, 14
    v_readlane_b32 s12, v16, s13
    s_waitcnt vmcnt(1)
    v_lshlrev_b32 v32, 16, v120
    v_and_b32 v36, s46, v120
    v_lshlrev_b32 v33, 16, v121
    v_and_b32 v37, s46, v121
    v_lshlrev_b32 v34, 16, v122
    v_and_b32 v38, s46, v122
    v_lshlrev_b32 v35, 16, v123
    v_and_b32 v39, s46, v123
    v_fmac_f32 v24, s12, v32
    v_fmac_f32 v28, s12, v36
    v_fmac_f32 v25, s12, v33
    v_fmac_f32 v29, s12, v37
    v_fmac_f32 v26, s12, v34
    v_fmac_f32 v30, s12, v38
    v_fmac_f32 v27, s12, v35
    v_fmac_f32 v31, s12, v39
    s_add_u32 s13, s6, 15
    v_readlane_b32 s12, v16, s13
    s_waitcnt vmcnt(0)
    v_lshlrev_b32 v32, 16, v124
    v_and_b32 v36, s46, v124
    v_lshlrev_b32 v33, 16, v125
    v_and_b32 v37, s46, v125
    v_lshlrev_b32 v34, 16, v126
    v_and_b32 v38, s46, v126
    v_lshlrev_b32 v35, 16, v127
    v_and_b32 v39, s46, v127
    v_fmac_f32 v24, s12, v32
    v_fmac_f32 v28, s12, v36
    v_fmac_f32 v25, s12, v33
    v_fmac_f32 v29, s12, v37
    v_fmac_f32 v26, s12, v34
    v_fmac_f32 v30, s12, v38
    v_fmac_f32 v27, s12, v35
    v_fmac_f32 v31, s12, v39
    buffer_load_dwordx4 v[192:195], v12, s[48:51], s86 offen nt
    s_add_u32 s86, s86, 1024
    buffer_load_dwordx4 v[196:199], v12, s[48:51], s86 offen nt
    s_add_u32 s86, s86, 1024
    buffer_load_dwordx4 v[200:203], v12, s[48:51], s86 offen nt
    s_add_u32 s86, s86, 1024
    buffer_load_dwordx4 v[204:207], v12, s[48:51], s86 offen nt
    s_add_u32 s86, s86, 1024
    buffer_load_dwordx4 v[208:211], v12, s[48:51], s86 offen nt
    s_add_u32 s86, s86, 1024
    buffer_load_dwordx4 v[212:215], v12, s[48:51], s86 offen nt
    s_add_u32 s86, s86, 1024
    buffer_load_dwordx4 v[216:219], v12, s[48:51], s86 offen nt
    s_add_u32 s86, s86, 1024
    buffer_load_dwordx4 v[220:223], v12, s[48:51], s86 offen nt
    s_add_u32 s86, s86, 1024
    buffer_load_dwordx4 v[224:227], v12, s[48:51], s86 offen nt
    s_add_u32 s86, s86, 1024
    buffer_load_dwordx4 v[228:231], v12, s[48:51], s86 offen nt
    s_add_u32 s86, s86, 1024
    buffer_load_dwordx4 v[232:235], v12, s[48:51], s86 offen nt
    s_add_u32 s86, s86, 1024
    buffer_load_dwordx4 v[236:239], v12, s[48:51], s86 offen nt
    s_add_u32 s86, s86, 1024
    buffer_load_dwordx4 v[240:243], v12, s[48:51], s86 offen nt
    s_add_u32 s86, s86, 1024
    buffer_load_dwordx4 v[244:247], v12, s[48:51], s86 offen nt
    s_add_u32 s86, s86, 1024
    buffer_load_dwordx4 v[248:251], v12, s[48:51], s86 offen nt
    s_add_u32 s86, s86, 1024
    buffer_load_dwordx4 v[252:255], v12, s[48:51], s86 offen nt
    s_add_u32 s86, s86, 1024
    v_lshrrev_b32 v10, 3, v2
    v_and_b32 v11, 7, v2
    v_lshlrev_b32 v11, 4, v11
    v_lshl_add_u32 v10, v10, 8, v11
    s_lshl_b32 s6, s5, 11
    v_add_u32 v10, s6, v10
    ds_write_b128 v10, v[24:27] offset:40960
    ds_write_b128 v10, v[28:31] offset:41088
    s_waitcnt lgkmcnt(0)
    s_barrier
    v_lshlrev_b32 v11, 3, v0
    ds_read_b64 v[32:33], v11 offset:40960
    ds_read_b64 v[34:35], v11 offset:43008
    ds_read_b64 v[36:37], v11 offset:45056
    ds_read_b64 v[38:39], v11 offset:47104
    s_waitcnt lgkmcnt(0)
    v_add_f32 v32, v32, v34
    v_add_f32 v33, v33, v35
    v_add_f32 v32, v32, v36
    v_add_f32 v33, v33, v37
    v_add_f32 v32, v32, v38
    v_add_f32 v33, v33, v39
    ds_write_b64 v11, v[32:33]
    s_waitcnt lgkmcnt(0)
    s_barrier
    s_lshl_b32 s6, s5, 9
    v_lshrrev_b32 v10, 3, v2
    v_lshlrev_b32 v10, 6, v10
    v_add_u32 v10, s6, v10
    ds_read_b128 v[64:67], v10 offset:0
    ds_read_b128 v[68:71], v10 offset:16
    ds_read_b128 v[72:75], v10 offset:32
    ds_read_b128 v[76:79], v10 offset:48
    v_mov_b32 v16, 0
    v_mov_b32 v17, 0
    v_mov_b32 v18, 0
    v_mov_b32 v19, 0
    v_mov_b32 v20, 0
    v_mov_b32 v21, 0
    v_mov_b32 v22, 0
    v_mov_b32 v23, 0
    s_waitcnt lgkmcnt(0)
    v_accvgpr_read_b32 v32, a0
    v_accvgpr_read_b32 v33, a1
    v_accvgpr_read_b32 v34, a2
    v_accvgpr_read_b32 v35, a3
    v_lshlrev_b32 v36, 16, v32
    v_and_b32 v40, s46, v32
    v_lshlrev_b32 v37, 16, v33
    v_and_b32 v41, s46, v33
    v_lshlrev_b32 v38, 16, v34
    v_and_b32 v42, s46, v34
    v_lshlrev_b32 v39, 16, v35
    v_and_b32 v43, s46, v35
    v_fmac_f32 v16, v36, v64
    v_fmac_f32 v17, v40, v64
    v_fmac_f32 v18, v37, v64
    v_fmac_f32 v19, v41, v64
    v_fmac_f32 v20, v38, v64
    v_fmac_f32 v21, v42, v64
    v_fmac_f32 v22, v39, v64
    v_fmac_f32 v23, v43, v64
    v_accvgpr_read_b32 v44, a4
    v_accvgpr_read_b32 v45, a5
    v_accvgpr_read_b32 v46, a6
    v_accvgpr_read_b32 v47, a7
    v_lshlrev_b32 v48, 16, v44
    v_and_b32 v52, s46, v44
    v_lshlrev_b32 v49, 16, v45
    v_and_b32 v53, s46, v45
    v_lshlrev_b32 v50, 16, v46
    v_and_b32 v54, s46, v46
    v_lshlrev_b32 v51, 16, v47
    v_and_b32 v55, s46, v47
    v_fmac_f32 v16, v48, v65
    v_fmac_f32 v17, v52, v65
    v_fmac_f32 v18, v49, v65
    v_fmac_f32 v19, v53, v65
    v_fmac_f32 v20, v50, v65
    v_fmac_f32 v21, v54, v65
    v_fmac_f32 v22, v51, v65
    v_fmac_f32 v23, v55, v65
    v_accvgpr_read_b32 v32, a8
    v_accvgpr_read_b32 v33, a9
    v_accvgpr_read_b32 v34, a10
    v_accvgpr_read_b32 v35, a11
    v_lshlrev_b32 v36, 16, v32
    v_and_b32 v40, s46, v32
    v_lshlrev_b32 v37, 16, v33
    v_and_b32 v41, s46, v33
    v_lshlrev_b32 v38, 16, v34
    v_and_b32 v42, s46, v34
    v_lshlrev_b32 v39, 16, v35
    v_and_b32 v43, s46, v35
    v_fmac_f32 v16, v36, v66
    v_fmac_f32 v17, v40, v66
    v_fmac_f32 v18, v37, v66
    v_fmac_f32 v19, v41, v66
    v_fmac_f32 v20, v38, v66
    v_fmac_f32 v21, v42, v66
    v_fmac_f32 v22, v39, v66
    v_fmac_f32 v23, v43, v66
    v_accvgpr_read_b32 v44, a12
    v_accvgpr_read_b32 v45, a13
    v_accvgpr_read_b32 v46, a14
    v_accvgpr_read_b32 v47, a15
    v_lshlrev_b32 v48, 16, v44
    v_and_b32 v52, s46, v44
    v_lshlrev_b32 v49, 16, v45
    v_and_b32 v53, s46, v45
    v_lshlrev_b32 v50, 16, v46
    v_and_b32 v54, s46, v46
    v_lshlrev_b32 v51, 16, v47
    v_and_b32 v55, s46, v47
    v_fmac_f32 v16, v48, v67
    v_fmac_f32 v17, v52, v67
    v_fmac_f32 v18, v49, v67
    v_fmac_f32 v19, v53, v67
    v_fmac_f32 v20, v50, v67
    v_fmac_f32 v21, v54, v67
    v_fmac_f32 v22, v51, v67
    v_fmac_f32 v23, v55, v67
    v_accvgpr_read_b32 v32, a16
    v_accvgpr_read_b32 v33, a17
    v_accvgpr_read_b32 v34, a18
    v_accvgpr_read_b32 v35, a19
    v_lshlrev_b32 v36, 16, v32
    v_and_b32 v40, s46, v32
    v_lshlrev_b32 v37, 16, v33
    v_and_b32 v41, s46, v33
    v_lshlrev_b32 v38, 16, v34
    v_and_b32 v42, s46, v34
    v_lshlrev_b32 v39, 16, v35
    v_and_b32 v43, s46, v35
    v_fmac_f32 v16, v36, v68
    v_fmac_f32 v17, v40, v68
    v_fmac_f32 v18, v37, v68
    v_fmac_f32 v19, v41, v68
    v_fmac_f32 v20, v38, v68
    v_fmac_f32 v21, v42, v68
    v_fmac_f32 v22, v39, v68
    v_fmac_f32 v23, v43, v68
    v_accvgpr_read_b32 v44, a20
    v_accvgpr_read_b32 v45, a21
    v_accvgpr_read_b32 v46, a22
    v_accvgpr_read_b32 v47, a23
    v_lshlrev_b32 v48, 16, v44
    v_and_b32 v52, s46, v44
    v_lshlrev_b32 v49, 16, v45
    v_and_b32 v53, s46, v45
    v_lshlrev_b32 v50, 16, v46
    v_and_b32 v54, s46, v46
    v_lshlrev_b32 v51, 16, v47
    v_and_b32 v55, s46, v47
    v_fmac_f32 v16, v48, v69
    v_fmac_f32 v17, v52, v69
    v_fmac_f32 v18, v49, v69
    v_fmac_f32 v19, v53, v69
    v_fmac_f32 v20, v50, v69
    v_fmac_f32 v21, v54, v69
    v_fmac_f32 v22, v51, v69
    v_fmac_f32 v23, v55, v69
    v_accvgpr_read_b32 v32, a24
    v_accvgpr_read_b32 v33, a25
    v_accvgpr_read_b32 v34, a26
    v_accvgpr_read_b32 v35, a27
    v_lshlrev_b32 v36, 16, v32
    v_and_b32 v40, s46, v32
    v_lshlrev_b32 v37, 16, v33
    v_and_b32 v41, s46, v33
    v_lshlrev_b32 v38, 16, v34
    v_and_b32 v42, s46, v34
    v_lshlrev_b32 v39, 16, v35
    v_and_b32 v43, s46, v35
    v_fmac_f32 v16, v36, v70
    v_fmac_f32 v17, v40, v70
    v_fmac_f32 v18, v37, v70
    v_fmac_f32 v19, v41, v70
    v_fmac_f32 v20, v38, v70
    v_fmac_f32 v21, v42, v70
    v_fmac_f32 v22, v39, v70
    v_fmac_f32 v23, v43, v70
    v_accvgpr_read_b32 v44, a28
    v_accvgpr_read_b32 v45, a29
    v_accvgpr_read_b32 v46, a30
    v_accvgpr_read_b32 v47, a31
    v_lshlrev_b32 v48, 16, v44
    v_and_b32 v52, s46, v44
    v_lshlrev_b32 v49, 16, v45
    v_and_b32 v53, s46, v45
    v_lshlrev_b32 v50, 16, v46
    v_and_b32 v54, s46, v46
    v_lshlrev_b32 v51, 16, v47
    v_and_b32 v55, s46, v47
    v_fmac_f32 v16, v48, v71
    v_fmac_f32 v17, v52, v71
    v_fmac_f32 v18, v49, v71
    v_fmac_f32 v19, v53, v71
    v_fmac_f32 v20, v50, v71
    v_fmac_f32 v21, v54, v71
    v_fmac_f32 v22, v51, v71
    v_fmac_f32 v23, v55, v71
    v_accvgpr_read_b32 v32, a32
    v_accvgpr_read_b32 v33, a33
    v_accvgpr_read_b32 v34, a34
    v_accvgpr_read_b32 v35, a35
    v_lshlrev_b32 v36, 16, v32
    v_and_b32 v40, s46, v32
    v_lshlrev_b32 v37, 16, v33
    v_and_b32 v41, s46, v33
    v_lshlrev_b32 v38, 16, v34
    v_and_b32 v42, s46, v34
    v_lshlrev_b32 v39, 16, v35
    v_and_b32 v43, s46, v35
    v_fmac_f32 v16, v36, v72
    v_fmac_f32 v17, v40, v72
    v_fmac_f32 v18, v37, v72
    v_fmac_f32 v19, v41, v72
    v_fmac_f32 v20, v38, v72
    v_fmac_f32 v21, v42, v72
    v_fmac_f32 v22, v39, v72
    v_fmac_f32 v23, v43, v72
    v_accvgpr_read_b32 v44, a36
    v_accvgpr_read_b32 v45, a37
    v_accvgpr_read_b32 v46, a38
    v_accvgpr_read_b32 v47, a39
    v_lshlrev_b32 v48, 16, v44
    v_and_b32 v52, s46, v44
    v_lshlrev_b32 v49, 16, v45
    v_and_b32 v53, s46, v45
    v_lshlrev_b32 v50, 16, v46
    v_and_b32 v54, s46, v46
    v_lshlrev_b32 v51, 16, v47
    v_and_b32 v55, s46, v47
    v_fmac_f32 v16, v48, v73
    v_fmac_f32 v17, v52, v73
    v_fmac_f32 v18, v49, v73
    v_fmac_f32 v19, v53, v73
    v_fmac_f32 v20, v50, v73
    v_fmac_f32 v21, v54, v73
    v_fmac_f32 v22, v51, v73
    v_fmac_f32 v23, v55, v73
    v_accvgpr_read_b32 v32, a40
    v_accvgpr_read_b32 v33, a41
    v_accvgpr_read_b32 v34, a42
    v_accvgpr_read_b32 v35, a43
    v_lshlrev_b32 v36, 16, v32
    v_and_b32 v40, s46, v32
    v_lshlrev_b32 v37, 16, v33
    v_and_b32 v41, s46, v33
    v_lshlrev_b32 v38, 16, v34
    v_and_b32 v42, s46, v34
    v_lshlrev_b32 v39, 16, v35
    v_and_b32 v43, s46, v35
    v_fmac_f32 v16, v36, v74
    v_fmac_f32 v17, v40, v74
    v_fmac_f32 v18, v37, v74
    v_fmac_f32 v19, v41, v74
    v_fmac_f32 v20, v38, v74
    v_fmac_f32 v21, v42, v74
    v_fmac_f32 v22, v39, v74
    v_fmac_f32 v23, v43, v74
    v_accvgpr_read_b32 v44, a44
    v_accvgpr_read_b32 v45, a45
    v_accvgpr_read_b32 v46, a46
    v_accvgpr_read_b32 v47, a47
    v_lshlrev_b32 v48, 16, v44
    v_and_b32 v52, s46, v44
    v_lshlrev_b32 v49, 16, v45
    v_and_b32 v53, s46, v45
    v_lshlrev_b32 v50, 16, v46
    v_and_b32 v54, s46, v46
    v_lshlrev_b32 v51, 16, v47
    v_and_b32 v55, s46, v47
    v_fmac_f32 v16, v48, v75
    v_fmac_f32 v17, v52, v75
    v_fmac_f32 v18, v49, v75
    v_fmac_f32 v19, v53, v75
    v_fmac_f32 v20, v50, v75
    v_fmac_f32 v21, v54, v75
    v_fmac_f32 v22, v51, v75
    v_fmac_f32 v23, v55, v75
    v_accvgpr_read_b32 v32, a48
    v_accvgpr_read_b32 v33, a49
    v_accvgpr_read_b32 v34, a50
    v_accvgpr_read_b32 v35, a51
    v_lshlrev_b32 v36, 16, v32
    v_and_b32 v40, s46, v32
    v_lshlrev_b32 v37, 16, v33
    v_and_b32 v41, s46, v33
    v_lshlrev_b32 v38, 16, v34
    v_and_b32 v42, s46, v34
    v_lshlrev_b32 v39, 16, v35
    v_and_b32 v43, s46, v35
    v_fmac_f32 v16, v36, v76
    v_fmac_f32 v17, v40, v76
    v_fmac_f32 v18, v37, v76
    v_fmac_f32 v19, v41, v76
    v_fmac_f32 v20, v38, v76
    v_fmac_f32 v21, v42, v76
    v_fmac_f32 v22, v39, v76
    v_fmac_f32 v23, v43, v76
    v_accvgpr_read_b32 v44, a52
    v_accvgpr_read_b32 v45, a53
    v_accvgpr_read_b32 v46, a54
    v_accvgpr_read_b32 v47, a55
    v_lshlrev_b32 v48, 16, v44
    v_and_b32 v52, s46, v44
    v_lshlrev_b32 v49, 16, v45
    v_and_b32 v53, s46, v45
    v_lshlrev_b32 v50, 16, v46
    v_and_b32 v54, s46, v46
    v_lshlrev_b32 v51, 16, v47
    v_and_b32 v55, s46, v47
    v_fmac_f32 v16, v48, v77
    v_fmac_f32 v17, v52, v77
    v_fmac_f32 v18, v49, v77
    v_fmac_f32 v19, v53, v77
    v_fmac_f32 v20, v50, v77
    v_fmac_f32 v21, v54, v77
    v_fmac_f32 v22, v51, v77
    v_fmac_f32 v23, v55, v77
    v_accvgpr_read_b32 v32, a56
    v_accvgpr_read_b32 v33, a57
    v_accvgpr_read_b32 v34, a58
    v_accvgpr_read_b32 v35, a59
    v_lshlrev_b32 v36, 16, v32
    v_and_b32 v40, s46, v32
    v_lshlrev_b32 v37, 16, v33
    v_and_b32 v41, s46, v33
    v_lshlrev_b32 v38, 16, v34
    v_and_b32 v42, s46, v34
    v_lshlrev_b32 v39, 16, v35
    v_and_b32 v43, s46, v35
    v_fmac_f32 v16, v36, v78
    v_fmac_f32 v17, v40, v78
    v_fmac_f32 v18, v37, v78
    v_fmac_f32 v19, v41, v78
    v_fmac_f32 v20, v38, v78
    v_fmac_f32 v21, v42, v78
    v_fmac_f32 v22, v39, v78
    v_fmac_f32 v23, v43, v78
    v_accvgpr_read_b32 v44, a60
    v_accvgpr_read_b32 v45, a61
    v_accvgpr_read_b32 v46, a62
    v_accvgpr_read_b32 v47, a63
    v_lshlrev_b32 v48, 16, v44
    v_and_b32 v52, s46, v44
    v_lshlrev_b32 v49, 16, v45
    v_and_b32 v53, s46, v45
    v_lshlrev_b32 v50, 16, v46
    v_and_b32 v54, s46, v46
    v_lshlrev_b32 v51, 16, v47
    v_and_b32 v55, s46, v47
    v_fmac_f32 v16, v48, v79
    v_fmac_f32 v17, v52, v79
    v_fmac_f32 v18, v49, v79
    v_fmac_f32 v19, v53, v79
    v_fmac_f32 v20, v50, v79
    v_fmac_f32 v21, v54, v79
    v_fmac_f32 v22, v51, v79
    v_fmac_f32 v23, v55, v79
    s_lshl_b32 s6, s5, 11
    v_lshlrev_b32 v10, 5, v2
    v_add_u32 v10, s6, v10
    ds_write_b128 v10, v[16:19] offset:4096
    ds_write_b128 v10, v[20:23] offset:4112
    s_waitcnt lgkmcnt(0)
    s_barrier
    s_cmp_lg_u32 s5, 0
    s_cbranch_scc1 K1A_F2
    v_lshlrev_b32 v10, 2, v2
    ds_read_b32 v32, v10 offset:4096
    ds_read_b32 v33, v10 offset:4352
    ds_read_b32 v34, v10 offset:4608
    ds_read_b32 v35, v10 offset:4864
    ds_read_b32 v36, v10 offset:5120
    ds_read_b32 v37, v10 offset:5376
    ds_read_b32 v38, v10 offset:5632
    ds_read_b32 v39, v10 offset:5888
    ds_read_b32 v40, v10 offset:6144
    ds_read_b32 v41, v10 offset:6400
    ds_read_b32 v42, v10 offset:6656
    ds_read_b32 v43, v10 offset:6912
    ds_read_b32 v44, v10 offset:7168
    ds_read_b32 v45, v10 offset:7424
    ds_read_b32 v46, v10 offset:7680
    ds_read_b32 v47, v10 offset:7936
    ds_read_b32 v48, v10 offset:8192
    ds_read_b32 v49, v10 offset:8448
    ds_read_b32 v50, v10 offset:8704
    ds_read_b32 v51, v10 offset:8960
    ds_read_b32 v52, v10 offset:9216
    ds_read_b32 v53, v10 offset:9472
    ds_read_b32 v54, v10 offset:9728
    ds_read_b32 v55, v10 offset:9984
    ds_read_b32 v56, v10 offset:10240
    ds_read_b32 v57, v10 offset:10496
    ds_read_b32 v58, v10 offset:10752
    ds_read_b32 v59, v10 offset:11008
    ds_read_b32 v60, v10 offset:11264
    ds_read_b32 v61, v10 offset:11520
    ds_read_b32 v62, v10 offset:11776
    ds_read_b32 v63, v10 offset:12032
    s_waitcnt lgkmcnt(0)
    v_add_f32 v32, v32, v33
    v_add_f32 v32, v32, v34
    v_add_f32 v32, v32, v35
    v_add_f32 v32, v32, v36
    v_add_f32 v32, v32, v37
    v_add_f32 v32, v32, v38
    v_add_f32 v32, v32, v39
    v_add_f32 v32, v32, v40
    v_add_f32 v32, v32, v41
    v_add_f32 v32, v32, v42
    v_add_f32 v32, v32, v43
    v_add_f32 v32, v32, v44
    v_add_f32 v32, v32, v45
    v_add_f32 v32, v32, v46
    v_add_f32 v32, v32, v47
    v_add_f32 v32, v32, v48
    v_add_f32 v32, v32, v49
    v_add_f32 v32, v32, v50
    v_add_f32 v32, v32, v51
    v_add_f32 v32, v32, v52
    v_add_f32 v32, v32, v53
    v_add_f32 v32, v32, v54
    v_add_f32 v32, v32, v55
    v_add_f32 v32, v32, v56
    v_add_f32 v32, v32, v57
    v_add_f32 v32, v32, v58
    v_add_f32 v32, v32, v59
    v_add_f32 v32, v32, v60
    v_add_f32 v32, v32, v61
    v_add_f32 v32, v32, v62
    v_add_f32 v32, v32, v63
    v_cvt_pk_bf16_f32 v32, v32, v32
    v_and_b32 v32, s46, v32
    ds_write_b32 v10, v32 offset:20480
K1A_F2:
    s_waitcnt lgkmcnt(0)
    s_barrier
    s_lshl_b32 s87, s7, 1
    s_add_u32 s87, s87, s15
    s_lshl_b32 s87, s87, 11
    s_lshl_b32 s13, s14, 17
    s_add_u32 s87, s87, s13
    s_add_u32 s87, s87, 0x80000
    s_lshl_b32 s6, s5, 6
    s_add_u32 s6, s6, 20480
    v_mov_b32 v10, s6
    ds_read_b128 v[64:67], v10 offset:0
    ds_read_b128 v[68:71], v10 offset:16
    ds_read_b128 v[72:75], v10 offset:32
    ds_read_b128 v[76:79], v10 offset:48
    v_mov_b32 v16, 0
    v_mov_b32 v17, 0
    v_mov_b32 v18, 0
    v_mov_b32 v19, 0
    v_mov_b32 v20, 0
    v_mov_b32 v21, 0
    v_mov_b32 v22, 0
    v_mov_b32 v23, 0
    s_waitcnt lgkmcnt(0)
    v_lshrrev_b32 v80, 16, v64
    v_lshrrev_b32 v81, 16, v65
    v_lshrrev_b32 v82, 16, v66
    v_lshrrev_b32 v83, 16, v67
    v_lshrrev_b32 v84, 16, v68
    v_lshrrev_b32 v85, 16, v69
    v_lshrrev_b32 v86, 16, v70
    v_lshrrev_b32 v87, 16, v71
    v_lshrrev_b32 v88, 16, v72
    v_lshrrev_b32 v89, 16, v73
    v_lshrrev_b32 v90, 16, v74
    v_lshrrev_b32 v91, 16, v75
    v_lshrrev_b32 v92, 16, v76
    v_lshrrev_b32 v93, 16, v77
    v_lshrrev_b32 v94, 16, v78
    v_lshrrev_b32 v95, 16, v79
    v_dot2c_f32_bf16 v16, v128, v80
    v_dot2c_f32_bf16 v17, v128, v64
    v_dot2c_f32_bf16 v18, v129, v80
    v_dot2c_f32_bf16 v19, v129, v64
    v_dot2c_f32_bf16 v20, v130, v80
    v_dot2c_f32_bf16 v21, v130, v64
    v_dot2c_f32_bf16 v22, v131, v80
    v_dot2c_f32_bf16 v23, v131, v64
    v_dot2c_f32_bf16 v16, v132, v81
    v_dot2c_f32_bf16 v17, v132, v65
    v_dot2c_f32_bf16 v18, v133, v81
    v_dot2c_f32_bf16 v19, v133, v65
    v_dot2c_f32_bf16 v20, v134, v81
    v_dot2c_f32_bf16 v21, v134, v65
    v_dot2c_f32_bf16 v22, v135, v81
    v_dot2c_f32_bf16 v23, v135, v65
    v_dot2c_f32_bf16 v16, v136, v82
    v_dot2c_f32_bf16 v17, v136, v66
    v_dot2c_f32_bf16 v18, v137, v82
    v_dot2c_f32_bf16 v19, v137, v66
    v_dot2c_f32_bf16 v20, v138, v82
    v_dot2c_f32_bf16 v21, v138, v66
    v_dot2c_f32_bf16 v22, v139, v82
    v_dot2c_f32_bf16 v23, v139, v66
    v_dot2c_f32_bf16 v16, v140, v83
    v_dot2c_f32_bf16 v17, v140, v67
    v_dot2c_f32_bf16 v18, v141, v83
    v_dot2c_f32_bf16 v19, v141, v67
    v_dot2c_f32_bf16 v20, v142, v83
    v_dot2c_f32_bf16 v21, v142, v67
    v_dot2c_f32_bf16 v22, v143, v83
    v_dot2c_f32_bf16 v23, v143, v67
    v_dot2c_f32_bf16 v16, v144, v84
    v_dot2c_f32_bf16 v17, v144, v68
    v_dot2c_f32_bf16 v18, v145, v84
    v_dot2c_f32_bf16 v19, v145, v68
    v_dot2c_f32_bf16 v20, v146, v84
    v_dot2c_f32_bf16 v21, v146, v68
    v_dot2c_f32_bf16 v22, v147, v84
    v_dot2c_f32_bf16 v23, v147, v68
    v_dot2c_f32_bf16 v16, v148, v85
    v_dot2c_f32_bf16 v17, v148, v69
    v_dot2c_f32_bf16 v18, v149, v85
    v_dot2c_f32_bf16 v19, v149, v69
    v_dot2c_f32_bf16 v20, v150, v85
    v_dot2c_f32_bf16 v21, v150, v69
    v_dot2c_f32_bf16 v22, v151, v85
    v_dot2c_f32_bf16 v23, v151, v69
    v_dot2c_f32_bf16 v16, v152, v86
    v_dot2c_f32_bf16 v17, v152, v70
    v_dot2c_f32_bf16 v18, v153, v86
    v_dot2c_f32_bf16 v19, v153, v70
    v_dot2c_f32_bf16 v20, v154, v86
    v_dot2c_f32_bf16 v21, v154, v70
    v_dot2c_f32_bf16 v22, v155, v86
    v_dot2c_f32_bf16 v23, v155, v70
    v_dot2c_f32_bf16 v16, v156, v87
    v_dot2c_f32_bf16 v17, v156, v71
    v_dot2c_f32_bf16 v18, v157, v87
    v_dot2c_f32_bf16 v19, v157, v71
    v_dot2c_f32_bf16 v20, v158, v87
    v_dot2c_f32_bf16 v21, v158, v71
    v_dot2c_f32_bf16 v22, v159, v87
    v_dot2c_f32_bf16 v23, v159, v71
    v_dot2c_f32_bf16 v16, v160, v88
    v_dot2c_f32_bf16 v17, v160, v72
    v_dot2c_f32_bf16 v18, v161, v88
    v_dot2c_f32_bf16 v19, v161, v72
    v_dot2c_f32_bf16 v20, v162, v88
    v_dot2c_f32_bf16 v21, v162, v72
    v_dot2c_f32_bf16 v22, v163, v88
    v_dot2c_f32_bf16 v23, v163, v72
    v_dot2c_f32_bf16 v16, v164, v89
    v_dot2c_f32_bf16 v17, v164, v73
    v_dot2c_f32_bf16 v18, v165, v89
    v_dot2c_f32_bf16 v19, v165, v73
    v_dot2c_f32_bf16 v20, v166, v89
    v_dot2c_f32_bf16 v21, v166, v73
    v_dot2c_f32_bf16 v22, v167, v89
    v_dot2c_f32_bf16 v23, v167, v73
    v_dot2c_f32_bf16 v16, v168, v90
    v_dot2c_f32_bf16 v17, v168, v74
    v_dot2c_f32_bf16 v18, v169, v90
    v_dot2c_f32_bf16 v19, v169, v74
    v_dot2c_f32_bf16 v20, v170, v90
    v_dot2c_f32_bf16 v21, v170, v74
    v_dot2c_f32_bf16 v22, v171, v90
    v_dot2c_f32_bf16 v23, v171, v74
    v_dot2c_f32_bf16 v16, v172, v91
    v_dot2c_f32_bf16 v17, v172, v75
    v_dot2c_f32_bf16 v18, v173, v91
    v_dot2c_f32_bf16 v19, v173, v75
    v_dot2c_f32_bf16 v20, v174, v91
    v_dot2c_f32_bf16 v21, v174, v75
    v_dot2c_f32_bf16 v22, v175, v91
    v_dot2c_f32_bf16 v23, v175, v75
    v_dot2c_f32_bf16 v16, v176, v92
    v_dot2c_f32_bf16 v17, v176, v76
    v_dot2c_f32_bf16 v18, v177, v92
    v_dot2c_f32_bf16 v19, v177, v76
    v_dot2c_f32_bf16 v20, v178, v92
    v_dot2c_f32_bf16 v21, v178, v76
    v_dot2c_f32_bf16 v22, v179, v92
    v_dot2c_f32_bf16 v23, v179, v76
    v_dot2c_f32_bf16 v16, v180, v93
    v_dot2c_f32_bf16 v17, v180, v77
    v_dot2c_f32_bf16 v18, v181, v93
    v_dot2c_f32_bf16 v19, v181, v77
    v_dot2c_f32_bf16 v20, v182, v93
    v_dot2c_f32_bf16 v21, v182, v77
    v_dot2c_f32_bf16 v22, v183, v93
    v_dot2c_f32_bf16 v23, v183, v77
    v_dot2c_f32_bf16 v16, v184, v94
    v_dot2c_f32_bf16 v17, v184, v78
    v_dot2c_f32_bf16 v18, v185, v94
    v_dot2c_f32_bf16 v19, v185, v78
    v_dot2c_f32_bf16 v20, v186, v94
    v_dot2c_f32_bf16 v21, v186, v78
    v_dot2c_f32_bf16 v22, v187, v94
    v_dot2c_f32_bf16 v23, v187, v78
    v_dot2c_f32_bf16 v16, v188, v95
    v_dot2c_f32_bf16 v17, v188, v79
    v_dot2c_f32_bf16 v18, v189, v95
    v_dot2c_f32_bf16 v19, v189, v79
    v_dot2c_f32_bf16 v20, v190, v95
    v_dot2c_f32_bf16 v21, v190, v79
    v_dot2c_f32_bf16 v22, v191, v95
    v_dot2c_f32_bf16 v23, v191, v79
    s_lshl_b32 s6, s5, 11
    v_lshlrev_b32 v10, 5, v2
    v_add_u32 v10, s6, v10
    s_nop 0
    ds_write_b128 v10, v[16:19] offset:24576
    ds_write_b128 v10, v[20:23] offset:24592
    s_waitcnt lgkmcnt(0)
    s_barrier
    v_lshlrev_b32 v11, 3, v0
    ds_read_b64 v[32:33], v11 offset:24576
    ds_read_b64 v[34:35], v11 offset:26624
    ds_read_b64 v[36:37], v11 offset:28672
    ds_read_b64 v[38:39], v11 offset:30720
    s_waitcnt lgkmcnt(0)
    v_add_f32 v32, v32, v34
    v_add_f32 v33, v33, v35
    v_add_f32 v32, v32, v36
    v_add_f32 v33, v33, v37
    v_add_f32 v32, v32, v38
    v_add_f32 v33, v33, v39
    buffer_store_dwordx2 v[32:33], v11, s[64:67], s87 offen
    s_cmp_lg_u32 s5, 0
    s_cbranch_scc1 K1A_P3_OK
K1A_P3_L:
    buffer_load_dword v11, off, s[72:75], s70 offset:128 sc1
    s_waitcnt vmcnt(0)
    v_readfirstlane_b32 s13, v11
    s_cmp_ge_u32 s13, 1024
    s_cbranch_scc1 K1A_P3_OK
    s_sleep 1
    s_branch K1A_P3_L
K1A_P3_OK:
    s_barrier
    s_cmp_lg_u32 s5, 0
    s_cbranch_scc1 K1A_F3
    s_lshl_b32 s6, s14, 5
    s_add_u32 s6, s6, s7
    s_lshl_b32 s6, s6, 11
    s_add_u32 s6, s6, 0x20000
    s_lshl_b32 s13, s15, 8
    v_lshlrev_b32 v10, 2, v2
    v_add_u32 v11, s13, v10
    buffer_load_dword v32, v11, s[64:67], s6 offen offset:0 sc1
    buffer_load_dwordx2 v[36:37], off, s[64:67], s6 offset:512 sc1
    buffer_load_dword v33, v11, s[64:67], s6 offen offset:1024 sc1
    buffer_load_dwordx2 v[38:39], off, s[64:67], s6 offset:1536 sc1
    s_waitcnt vmcnt(0)
    v_max_f32 v40, v36, v38
    v_sub_f32 v36, v36, v40
    v_mul_f32 v36, s47, v36
    v_exp_f32 v36, v36
    v_sub_f32 v38, v38, v40
    v_mul_f32 v38, s47, v38
    v_exp_f32 v38, v38
    s_nop 0
    v_mul_f32 v41, v36, v37
    v_fmac_f32 v41, v38, v39
    v_mul_f32 v42, v36, v32
    v_fmac_f32 v42, v38, v33
    v_rcp_f32 v41, v41
    s_nop 0
    v_mul_f32 v42, v42, v41
    v_cvt_pk_bf16_f32 v42, v42, v42
    v_and_b32 v42, s46, v42
    ds_write_b32 v10, v42 offset:20992
K1A_F3:
    s_waitcnt vmcnt(0) lgkmcnt(0)
    s_barrier
    s_add_u32 s87, s87, 0x40000
    s_lshl_b32 s6, s5, 6
    s_add_u32 s6, s6, 20992
    v_mov_b32 v10, s6
    ds_read_b128 v[64:67], v10 offset:0
    ds_read_b128 v[68:71], v10 offset:16
    ds_read_b128 v[72:75], v10 offset:32
    ds_read_b128 v[76:79], v10 offset:48
    v_mov_b32 v16, 0
    v_mov_b32 v17, 0
    v_mov_b32 v18, 0
    v_mov_b32 v19, 0
    v_mov_b32 v20, 0
    v_mov_b32 v21, 0
    v_mov_b32 v22, 0
    v_mov_b32 v23, 0
    s_waitcnt lgkmcnt(0)
    v_lshrrev_b32 v80, 16, v64
    v_lshrrev_b32 v81, 16, v65
    v_lshrrev_b32 v82, 16, v66
    v_lshrrev_b32 v83, 16, v67
    v_lshrrev_b32 v84, 16, v68
    v_lshrrev_b32 v85, 16, v69
    v_lshrrev_b32 v86, 16, v70
    v_lshrrev_b32 v87, 16, v71
    v_lshrrev_b32 v88, 16, v72
    v_lshrrev_b32 v89, 16, v73
    v_lshrrev_b32 v90, 16, v74
    v_lshrrev_b32 v91, 16, v75
    v_lshrrev_b32 v92, 16, v76
    v_lshrrev_b32 v93, 16, v77
    v_lshrrev_b32 v94, 16, v78
    v_lshrrev_b32 v95, 16, v79
    v_dot2c_f32_bf16 v16, v192, v80
    v_dot2c_f32_bf16 v17, v192, v64
    v_dot2c_f32_bf16 v18, v193, v80
    v_dot2c_f32_bf16 v19, v193, v64
    v_dot2c_f32_bf16 v20, v194, v80
    v_dot2c_f32_bf16 v21, v194, v64
    v_dot2c_f32_bf16 v22, v195, v80
    v_dot2c_f32_bf16 v23, v195, v64
    v_dot2c_f32_bf16 v16, v196, v81
    v_dot2c_f32_bf16 v17, v196, v65
    v_dot2c_f32_bf16 v18, v197, v81
    v_dot2c_f32_bf16 v19, v197, v65
    v_dot2c_f32_bf16 v20, v198, v81
    v_dot2c_f32_bf16 v21, v198, v65
    v_dot2c_f32_bf16 v22, v199, v81
    v_dot2c_f32_bf16 v23, v199, v65
    v_dot2c_f32_bf16 v16, v200, v82
    v_dot2c_f32_bf16 v17, v200, v66
    v_dot2c_f32_bf16 v18, v201, v82
    v_dot2c_f32_bf16 v19, v201, v66
    v_dot2c_f32_bf16 v20, v202, v82
    v_dot2c_f32_bf16 v21, v202, v66
    v_dot2c_f32_bf16 v22, v203, v82
    v_dot2c_f32_bf16 v23, v203, v66
    v_dot2c_f32_bf16 v16, v204, v83
    v_dot2c_f32_bf16 v17, v204, v67
    v_dot2c_f32_bf16 v18, v205, v83
    v_dot2c_f32_bf16 v19, v205, v67
    v_dot2c_f32_bf16 v20, v206, v83
    v_dot2c_f32_bf16 v21, v206, v67
    v_dot2c_f32_bf16 v22, v207, v83
    v_dot2c_f32_bf16 v23, v207, v67
    v_dot2c_f32_bf16 v16, v208, v84
    v_dot2c_f32_bf16 v17, v208, v68
    v_dot2c_f32_bf16 v18, v209, v84
    v_dot2c_f32_bf16 v19, v209, v68
    v_dot2c_f32_bf16 v20, v210, v84
    v_dot2c_f32_bf16 v21, v210, v68
    v_dot2c_f32_bf16 v22, v211, v84
    v_dot2c_f32_bf16 v23, v211, v68
    v_dot2c_f32_bf16 v16, v212, v85
    v_dot2c_f32_bf16 v17, v212, v69
    v_dot2c_f32_bf16 v18, v213, v85
    v_dot2c_f32_bf16 v19, v213, v69
    v_dot2c_f32_bf16 v20, v214, v85
    v_dot2c_f32_bf16 v21, v214, v69
    v_dot2c_f32_bf16 v22, v215, v85
    v_dot2c_f32_bf16 v23, v215, v69
    v_dot2c_f32_bf16 v16, v216, v86
    v_dot2c_f32_bf16 v17, v216, v70
    v_dot2c_f32_bf16 v18, v217, v86
    v_dot2c_f32_bf16 v19, v217, v70
    v_dot2c_f32_bf16 v20, v218, v86
    v_dot2c_f32_bf16 v21, v218, v70
    v_dot2c_f32_bf16 v22, v219, v86
    v_dot2c_f32_bf16 v23, v219, v70
    v_dot2c_f32_bf16 v16, v220, v87
    v_dot2c_f32_bf16 v17, v220, v71
    v_dot2c_f32_bf16 v18, v221, v87
    v_dot2c_f32_bf16 v19, v221, v71
    v_dot2c_f32_bf16 v20, v222, v87
    v_dot2c_f32_bf16 v21, v222, v71
    v_dot2c_f32_bf16 v22, v223, v87
    v_dot2c_f32_bf16 v23, v223, v71
    v_dot2c_f32_bf16 v16, v224, v88
    v_dot2c_f32_bf16 v17, v224, v72
    v_dot2c_f32_bf16 v18, v225, v88
    v_dot2c_f32_bf16 v19, v225, v72
    v_dot2c_f32_bf16 v20, v226, v88
    v_dot2c_f32_bf16 v21, v226, v72
    v_dot2c_f32_bf16 v22, v227, v88
    v_dot2c_f32_bf16 v23, v227, v72
    v_dot2c_f32_bf16 v16, v228, v89
    v_dot2c_f32_bf16 v17, v228, v73
    v_dot2c_f32_bf16 v18, v229, v89
    v_dot2c_f32_bf16 v19, v229, v73
    v_dot2c_f32_bf16 v20, v230, v89
    v_dot2c_f32_bf16 v21, v230, v73
    v_dot2c_f32_bf16 v22, v231, v89
    v_dot2c_f32_bf16 v23, v231, v73
    v_dot2c_f32_bf16 v16, v232, v90
    v_dot2c_f32_bf16 v17, v232, v74
    v_dot2c_f32_bf16 v18, v233, v90
    v_dot2c_f32_bf16 v19, v233, v74
    v_dot2c_f32_bf16 v20, v234, v90
    v_dot2c_f32_bf16 v21, v234, v74
    v_dot2c_f32_bf16 v22, v235, v90
    v_dot2c_f32_bf16 v23, v235, v74
    v_dot2c_f32_bf16 v16, v236, v91
    v_dot2c_f32_bf16 v17, v236, v75
    v_dot2c_f32_bf16 v18, v237, v91
    v_dot2c_f32_bf16 v19, v237, v75
    v_dot2c_f32_bf16 v20, v238, v91
    v_dot2c_f32_bf16 v21, v238, v75
    v_dot2c_f32_bf16 v22, v239, v91
    v_dot2c_f32_bf16 v23, v239, v75
    v_dot2c_f32_bf16 v16, v240, v92
    v_dot2c_f32_bf16 v17, v240, v76
    v_dot2c_f32_bf16 v18, v241, v92
    v_dot2c_f32_bf16 v19, v241, v76
    v_dot2c_f32_bf16 v20, v242, v92
    v_dot2c_f32_bf16 v21, v242, v76
    v_dot2c_f32_bf16 v22, v243, v92
    v_dot2c_f32_bf16 v23, v243, v76
    v_dot2c_f32_bf16 v16, v244, v93
    v_dot2c_f32_bf16 v17, v244, v77
    v_dot2c_f32_bf16 v18, v245, v93
    v_dot2c_f32_bf16 v19, v245, v77
    v_dot2c_f32_bf16 v20, v246, v93
    v_dot2c_f32_bf16 v21, v246, v77
    v_dot2c_f32_bf16 v22, v247, v93
    v_dot2c_f32_bf16 v23, v247, v77
    v_dot2c_f32_bf16 v16, v248, v94
    v_dot2c_f32_bf16 v17, v248, v78
    v_dot2c_f32_bf16 v18, v249, v94
    v_dot2c_f32_bf16 v19, v249, v78
    v_dot2c_f32_bf16 v20, v250, v94
    v_dot2c_f32_bf16 v21, v250, v78
    v_dot2c_f32_bf16 v22, v251, v94
    v_dot2c_f32_bf16 v23, v251, v78
    v_dot2c_f32_bf16 v16, v252, v95
    v_dot2c_f32_bf16 v17, v252, v79
    v_dot2c_f32_bf16 v18, v253, v95
    v_dot2c_f32_bf16 v19, v253, v79
    v_dot2c_f32_bf16 v20, v254, v95
    v_dot2c_f32_bf16 v21, v254, v79
    v_dot2c_f32_bf16 v22, v255, v95
    v_dot2c_f32_bf16 v23, v255, v79
    s_lshl_b32 s6, s5, 11
    v_lshlrev_b32 v10, 5, v2
    v_add_u32 v10, s6, v10
    s_nop 0
    ds_write_b128 v10, v[16:19] offset:32768
    ds_write_b128 v10, v[20:23] offset:32784
    s_waitcnt lgkmcnt(0)
    s_barrier
    v_lshlrev_b32 v11, 3, v0
    ds_read_b64 v[32:33], v11 offset:32768
    ds_read_b64 v[34:35], v11 offset:34816
    ds_read_b64 v[36:37], v11 offset:36864
    ds_read_b64 v[38:39], v11 offset:38912
    s_waitcnt lgkmcnt(0)
    v_add_f32 v32, v32, v34
    v_add_f32 v33, v33, v35
    v_add_f32 v32, v32, v36
    v_add_f32 v33, v33, v37
    v_add_f32 v32, v32, v38
    v_add_f32 v33, v33, v39
    buffer_store_dwordx2 v[32:33], v11, s[64:67], s87 offen
K1_END:
    s_endpgm
.globl k2_kernel
.p2align 8
.type k2_kernel,@function
k2_kernel:
    s_cmp_ge_u32 s2, 32
    s_cbranch_scc1 K2_END
    s_load_dwordx16 s[16:31], s[0:1], 0
    s_load_dwordx8 s[32:39], s[0:1], 64
    s_load_dwordx4 s[40:43], s[0:1], 96
    v_lshrrev_b32 v1, 6, v0
    v_and_b32 v2, 63, v0
    v_readfirstlane_b32 s5, v1
    s_lshr_b32 s8, s2, 4
    s_bfe_u32 s9, s2, 0x10003
    s_and_b32 s10, s2, 7
    s_lshl_b32 s6, s9, 1
    s_add_u32 s6, s6, s8
    s_lshl_b32 s6, s6, 17
    s_lshl_b32 s11, s5, 15
    s_add_u32 s6, s6, s11
    s_lshl_b32 s12, s10, 8
    s_add_u32 s6, s6, s12
    s_add_u32 s6, s6, 0x80000
    v_lshlrev_b32 v10, 2, v2
    s_waitcnt lgkmcnt(0)
    s_mov_b32 s64, s42
    s_mov_b32 s65, s43
    s_mov_b32 s66, 8388608
    s_mov_b32 s67, 0x00020000
    s_mov_b32 s48, s38
    s_mov_b32 s49, s39
    s_mov_b32 s50, 4096
    s_mov_b32 s51, 0x00020000
    buffer_load_dword v32, v10, s[64:67], s6 offen
    s_add_u32 s6, s6, 2048
    buffer_load_dword v33, v10, s[64:67], s6 offen
    s_add_u32 s6, s6, 2048
    buffer_load_dword v34, v10, s[64:67], s6 offen
    s_add_u32 s6, s6, 2048
    buffer_load_dword v35, v10, s[64:67], s6 offen
    s_add_u32 s6, s6, 2048
    buffer_load_dword v36, v10, s[64:67], s6 offen
    s_add_u32 s6, s6, 2048
    buffer_load_dword v37, v10, s[64:67], s6 offen
    s_add_u32 s6, s6, 2048
    buffer_load_dword v38, v10, s[64:67], s6 offen
    s_add_u32 s6, s6, 2048
    buffer_load_dword v39, v10, s[64:67], s6 offen
    s_add_u32 s6, s6, 2048
    buffer_load_dword v40, v10, s[64:67], s6 offen
    s_add_u32 s6, s6, 2048
    buffer_load_dword v41, v10, s[64:67], s6 offen
    s_add_u32 s6, s6, 2048
    buffer_load_dword v42, v10, s[64:67], s6 offen
    s_add_u32 s6, s6, 2048
    buffer_load_dword v43, v10, s[64:67], s6 offen
    s_add_u32 s6, s6, 2048
    buffer_load_dword v44, v10, s[64:67], s6 offen
    s_add_u32 s6, s6, 2048
    buffer_load_dword v45, v10, s[64:67], s6 offen
    s_add_u32 s6, s6, 2048
    buffer_load_dword v46, v10, s[64:67], s6 offen
    s_add_u32 s6, s6, 2048
    buffer_load_dword v47, v10, s[64:67], s6 offen
    s_add_u32 s6, s6, 2048
    s_waitcnt vmcnt(0)
    v_add_f32 v32, v32, v33
    v_add_f32 v32, v32, v34
    v_add_f32 v32, v32, v35
    v_add_f32 v32, v32, v36
    v_add_f32 v32, v32, v37
    v_add_f32 v32, v32, v38
    v_add_f32 v32, v32, v39
    v_add_f32 v32, v32, v40
    v_add_f32 v32, v32, v41
    v_add_f32 v32, v32, v42
    v_add_f32 v32, v32, v43
    v_add_f32 v32, v32, v44
    v_add_f32 v32, v32, v45
    v_add_f32 v32, v32, v46
    v_add_f32 v32, v32, v47
    v_lshlrev_b32 v11, 2, v0
    ds_write_b32 v11, v32
    s_waitcnt lgkmcnt(0)
    s_barrier
    s_cmp_lg_u32 s5, 0
    s_cbranch_scc1 K2_END
    ds_read_b32 v20, v10 offset:0
    ds_read_b32 v21, v10 offset:256
    ds_read_b32 v22, v10 offset:512
    ds_read_b32 v23, v10 offset:768
    s_waitcnt lgkmcnt(0)
    v_add_f32 v20, v20, v21
    v_add_f32 v22, v22, v23
    v_add_f32 v20, v20, v22
    v_cvt_pk_bf16_f32 v20, v20, v20
    s_lshl_b32 s6, s2, 7
    v_lshlrev_b32 v11, 1, v2
    buffer_store_short v20, v11, s[48:51], s6 offen
K2_END:
    s_endpgm
.section .rodata,"a"
.p2align 6
.amdhsa_kernel k1_kernel
  .amdhsa_next_free_vgpr 512
  .amdhsa_next_free_sgpr 102
  .amdhsa_accum_offset 256
  .amdhsa_group_segment_fixed_size 0
  .amdhsa_kernarg_size 112
  .amdhsa_user_sgpr_count 2
  .amdhsa_user_sgpr_kernarg_segment_ptr 1
  .amdhsa_system_sgpr_workgroup_id_x 1
.end_amdhsa_kernel
.p2align 6
.amdhsa_kernel k2_kernel
  .amdhsa_next_free_vgpr 128
  .amdhsa_next_free_sgpr 102
  .amdhsa_accum_offset 128
  .amdhsa_group_segment_fixed_size 0
  .amdhsa_kernarg_size 112
  .amdhsa_user_sgpr_count 2
  .amdhsa_user_sgpr_kernarg_segment_ptr 1
  .amdhsa_system_sgpr_workgroup_id_x 1
.end_amdhsa_kernel
```
